```python
import torch

def _softmax(x, axis=-1):
    return torch.softmax(x, dim=axis)
def _gelu(x):
    return torch.nn.functional.gelu(x, approximate="tanh")
def _silu(x):
    return torch.nn.functional.silu(x)
def _sigmoid(x):
    return torch.sigmoid(x)
def _layernorm(x, axis=-1, eps=1e-5):
    m = x.mean(dim=axis, keepdim=True)
    v = x.var(dim=axis, keepdim=True, unbiased=False)
    return (x - m) / torch.sqrt(v + eps)
def _scatter_add(tgt, idx, src, axis=0):
    return tgt.clone().index_add_(axis, idx, src)
def _segment_sum(src, seg, n):
    out = torch.zeros((n,) + src.shape[1:], dtype=src.dtype)
    return out.index_add_(0, seg, src)
def _pad(x, pw):
    flat = tuple(v for pair in reversed(pw) for v in pair)
    return torch.nn.functional.pad(x, flat)

kernel_name = 'parallel_sum__linear_attn_block__dense_activation_mish__prompt'

def setup_inputs():

    _w = (lambda a: (lambda t: t.to(torch.bfloat16) if t.is_floating_point() else t)(torch.as_tensor(a)))
    def _A_setup():
        B, S, D = 1, 2048, 512
        return {
            "x": _w((lambda *s: torch.randn(*s, dtype=torch.bfloat16) * 0.05)(B, S, D)),
            "wqkv": _w((lambda *s: torch.randn(*s, dtype=torch.bfloat16) * 0.1)(D, 3 * D)),
            "wo": _w((lambda *s: torch.randn(*s, dtype=torch.bfloat16) * 0.05)(D, D)),
        }
    _A_in = _A_setup()

    def _B_setup():
        B, S, D, F = 1, 2048, 512, 1376
        return {
            "x": _w((lambda *s: torch.randn(*s, dtype=torch.bfloat16) * 0.05)(B, S, D)),
            "w1": _w((lambda *s: torch.randn(*s, dtype=torch.bfloat16) * 0.8)(D, F) * (D ** -0.5)),
            "b1": _w((lambda *s: torch.randn(*s, dtype=torch.bfloat16) * 0.4)(F)),
            "w2": _w((lambda *s: torch.randn(*s, dtype=torch.bfloat16) * 0.1)(F, D) * (F ** -0.5)),
        }
    _B_in = _B_setup()

    return {
        "A_x": _A_in["x"],
        "A_wqkv": _A_in["wqkv"],
        "A_wo": _A_in["wo"],
        "B_x": _B_in["x"],
        "B_w1": _B_in["w1"],
        "B_b1": _B_in["b1"],
        "B_w2": _B_in["w2"],
    }

def reference(A_x, A_wqkv, A_wo, B_x, B_w1, B_b1, B_w2):
    def _A_ref(x, wqkv, wo):
        B, S, D = x.shape
        H = 32; Dh = D // H
        qkv = (lambda x, *d: x.permute(*d))((x @ wqkv).reshape(B, S, 3, H, Dh), 2, 0, 3, 1, 4)
        q, k, v = qkv[0], qkv[1], qkv[2]
        phi = lambda t: torch.where(t > 0, t + 1, torch.exp(t)) + 1e-6
        pq, pk = phi(q), phi(k)
        kv = torch.einsum("bhsd,bhse->bhde", pk, v)
        z = torch.einsum("bhsd->bhd", pk)
        num = torch.einsum("bhqd,bhde->bhqe", pq, kv)
        den = torch.einsum("bhqd,bhd->bhq", pq, z)[..., None] + 1e-6
        o = num / den
        return (lambda x, *d: x.permute(*d))(o, 0, 2, 1, 3).reshape(B, S, D) @ wo

    def _B_ref(x, w1, b1, w2):
        h = torch.einsum("bsd,df->bsf", x, w1) + b1
        sp = torch.log1p(torch.exp(-torch.abs(h))) + torch.where(h > 0, h, torch.zeros_like(h))
        act = h * torch.tanh(sp)
        return torch.einsum("bsf,fd->bsd", act, w2)

    x = A_x
    xn = _layernorm(x, axis=-1)
    return x + _A_ref(xn, A_wqkv, A_wo) + _B_ref(xn, B_w1, B_b1, B_w2)
```

```asm
; @launch grid=(256,1,1) block=(256,1,1) lds=163840
.amdgcn_target "amdgcn-amd-amdhsa--gfx950"
.text
.globl parallel_sum__linear_attn_block__dense_activation_mish__prompt_kernel
.p2align 8
.type parallel_sum__linear_attn_block__dense_activation_mish__prompt_kernel,@function
parallel_sum__linear_attn_block__dense_activation_mish__prompt_kernel:
    s_lshr_b32 s55, s2, 8
    s_cbranch_scc1 L_end
    s_load_dwordx2 s[4:5], s[0:1], 0
    s_load_dwordx16 s[64:79], s[0:1], 0
    s_load_dwordx2 s[32:33], s[0:1], 72
    v_lshrrev_b32 v6, 6, v0
    v_and_b32 v1, 63, v0
    v_readfirstlane_b32 s3, v6
    s_lshl_b32 s7, 1, 17
    s_getpc_b64 s[92:93]
    s_lshr_b32 s92, s92, 8
    s_lshl_b32 s92, s92, 8
    s_mov_b32 s94, L_codeend-parallel_sum__linear_attn_block__dense_activation_mish__prompt_kernel
    s_mov_b32 s95, s7
    v_lshrrev_b32 v238, 4, v0
    v_lshlrev_b32 v238, 7, v238
    s_lshr_b32 s56, s2, 3
    s_lshl_b32 s55, s56, 11
    buffer_load_dword v176, v238, s[92:95], s55 offen
    s_lshl_b32 s6, 1, 21
    s_and_b32 s55, s2, 6
    s_lshr_b32 s57, s2, 6
    s_lshl1_add_u32 s36, s55, s57
    s_lshl1_add_u32 s57, s57, s55
    s_and_b32 s57, s57, 7
    s_and_b32 s58, s2, 57
    s_cmp_eq_u32 s58, 24
    s_cselect_b32 s55, s57, s55
    s_lshl_b32 s45, s55, 7
    v_lshrrev_b32 v240, 3, v1
    v_and_b32 v241, 7, v1
    s_lshl2_add_u32 s57, s36, s3
    s_lshl_b32 s57, s57, 15
    v_lshl_add_u32 v243, v240, 10, s57
    v_lshrrev_b32 v244, 1, v240
    v_xor_b32 v244, v244, v241
    v_lshl_add_u32 v8, v244, 4, v243
    v_xor_b32 v9, 64, v8
    v_add_u32 v9, 7168, v9
    v_add_u32 v10, 14336, v8
    v_add_u32 v11, 14336, v9
    s_lshl_b32 s50, s3, 13
    s_add_u32 m0, s50, 8192
    s_waitcnt lgkmcnt(0)
    buffer_load_dwordx4 v8, s[4:7], s45 offen lds
    buffer_load_dwordx4 v9, s[4:7], s45 offen offset:1024 lds
    buffer_load_dwordx4 v10, s[4:7], s45 offen offset:2048 lds
    buffer_load_dwordx4 v11, s[4:7], s45 offen offset:3072 lds
L_first256:
    s_and_b32 s37, s56, 7
    s_and_b32 s55, s2, 1
    s_lshl1_add_u32 s37, s37, s55
    v_lshlrev_b32 v2, 4, v1
    s_lshl4_add_u32 s62, s36, s37
    s_lshl2_add_u32 s62, s62, s3
    s_lshl_b32 s63, s62, 11
    buffer_load_dwordx4 v[224:227], v2, s[4:7], s63 offen
    buffer_load_dwordx4 v[228:231], v2, s[4:7], s63 offen offset:1024
    s_load_dword s61, s[32:33], 0
    s_lshr_b32 s38, s37, 1
    v_lshl_add_u32 v239, v6, 4, v240
    v_lshlrev_b32 v242, 1, v240
    v_and_b32 v242, 4, v242
    v_xor_b32 v242, v242, v241
    v_lshlrev_b32 v242, 4, v242
    s_mul_i32 s0, s38, 6
    s_add_u32 s1, s0, 2
    s_cmp_eq_u32 s38, 7
    s_cselect_b32 s58, 16776704, s1
    s_lshl1_add_u32 s55, s38, 16
    s_lshl1_add_u32 s56, s38, 32
    s_movk_i32 s57, 3072
    s_bitcmp1_b32 s37, 0
    s_cselect_b32 s55, s0, s55
    s_cselect_b32 s56, s58, s56
    s_cselect_b32 s57, 2752, s57
    s_cselect_b64 s[80:81], s[72:73], s[66:67]
    s_lshl_b32 s82, s57, 9
    s_mov_b32 s83, s7
    v_mul_u32_u24 v238, s57, v239
    s_lshl_b32 s55, s55, 6
    s_lshl_b32 s56, s56, 6
    s_lshl_b32 s58, s57, 3
    s_sub_u32 s58, s58, 1024
    v_add3_u32 v12, v238, v242, s55
    v_add3_u32 v14, v238, v242, s56
    s_lshr_b32 s57, s57, 1
    s_mul_i32 s54, s45, s57
    s_add_u32 m0, s50, 12288
    v_add_u32 v13, s58, v12
    v_add_u32 v15, s58, v14
    buffer_load_dwordx4 v12, s[80:83], s54 offen lds
    buffer_load_dwordx4 v13, s[80:83], s54 offen offset:1024 lds
    s_add_u32 m0, s50, 14336
    s_lshl_b32 s62, s62, 1
    buffer_load_dwordx4 v14, s[80:83], s54 offen lds
    buffer_load_dwordx4 v15, s[80:83], s54 offen offset:1024 lds
    s_mov_b64 s[8:9], s[66:67]
    s_mov_b64 s[16:17], s[68:69]
    s_mov_b64 s[12:13], s[72:73]
    s_mov_b64 s[24:25], s[74:75]
    s_mov_b64 s[20:21], s[76:77]
    s_mov_b64 s[28:29], s[78:79]
    s_mov_b32 s10, 1572864
    s_mov_b32 s11, 0x20000
    s_mov_b32 s14, 1409024
    s_mov_b32 s15, 0x20000
    s_mov_b32 s34, 33554432
    s_mov_b32 s35, 0x20000
    s_mov_b32 s22, 1409024
    s_mov_b32 s23, 0x20000
    s_mov_b32 s18, 524288
    s_mov_b32 s19, 0x20000
    s_and_b32 s39, s3, 1
    s_lshr_b32 s40, s3, 1
    s_add_u32 s77, s45, 128
    s_and_b32 s77, s77, 0x380
    s_add_u32 s78, s77, 128
    s_and_b32 s78, s78, 0x380
    s_add_u32 s79, s78, 128
    s_and_b32 s79, s79, 0x380
    s_add_u32 s80, s79, 128
    s_and_b32 s80, s80, 0x380
    s_add_u32 s81, s80, 128
    s_and_b32 s81, s81, 0x380
    s_add_u32 s82, s81, 128
    s_and_b32 s82, s82, 0x380
    s_add_u32 s83, s82, 128
    s_and_b32 s83, s83, 0x380
    v_and_b32 v232, 31, v1
    v_lshrrev_b32 v233, 5, v1
    v_lshlrev_b32 v167, 2, v232
    v_bfe_u32 v234, v232, 1, 3
    v_xor_b32 v234, v234, v233
    s_lshl_b32 s55, s39, 14
    s_add_u32 s55, s55, 8192
    v_lshl_add_u32 v235, v232, 7, s55
    s_lshl_b32 s56, s39, 1
    v_xor_b32 v234, s56, v234
    v_lshl_add_u32 v18, v234, 4, v235
    v_xor_b32 v19, 32, v18
    v_xor_b32 v20, 64, v18
    v_xor_b32 v21, 96, v18
    v_add_u32 v22, 65536, v18
    v_add_u32 v23, 65536, v19
    v_add_u32 v24, 65536, v20
    v_add_u32 v25, 65536, v21
    v_bfe_u32 v234, v1, 2, 2
    v_bfe_u32 v238, v1, 4, 1
    v_lshlrev_b32 v238, 5, v238
    v_and_b32 v236, 3, v1
    v_lshl_add_u32 v238, v236, 3, v238
    v_lshrrev_b32 v236, 1, v234
    v_xor_b32 v236, s40, v236
    v_lshl_add_u32 v236, v236, 6, v238
    v_lshl_add_u32 v237, v233, 3, v234
    v_lshl_add_u32 v237, v237, 7, v236
    s_lshl_b32 s55, s39, 13
    s_add_u32 s56, s55, 12288
    s_sub_u32 s57, 20480, s55
    v_add_u32 v26, s56, v237
    v_add_u32 v27, s57, v237
    v_add_u32 v28, 65536, v26
    v_add_u32 v29, 65536, v27
    v_lshrrev_b32 v234, 2, v1
    v_xor_b32 v234, v234, v1
    v_and_b32 v234, 4, v234
    v_cmp_eq_u32 vcc, 0, v234
    v_mov_b32 v189, 0x3f803f80
    s_nop 0
    v_cndmask_b32 v32, 0, v189, vcc
    v_cndmask_b32 v33, 0, v189, vcc
    v_cndmask_b32 v34, 0, v189, vcc
    v_cndmask_b32 v35, 0, v189, vcc
    v_cmp_eq_u32 vcc, 63, v1
    v_mov_b32 v212, 2147418112
    s_lshl_b32 s62, s62, 3
    s_add_u32 s62, s62, 4096
    v_cndmask_b32 v212, v212, 0, vcc
    s_add_u32 s55, s2, 0
    s_and_b32 s55, s55, 255
    s_mul_i32 s56, s55, 43
    s_mul_i32 s57, s3, 22
    s_add_u32 s56, s56, s57
    s_lshl_b32 s57, s55, 4
    s_cmp_ge_u32 s3, 2
    s_cselect_b32 s56, s57, s56
    s_cselect_b32 s84, s16, s20
    s_cselect_b32 s85, s17, s21
    s_lshl_b32 s56, s56, 7
    s_add_u32 s84, s84, s56
    s_addc_u32 s85, s85, 0
    s_lshl_b32 s57, s3, 3
    s_lshr_b32 s86, 1053974, s57
    s_and_b32 s86, s86, 0xff
    s_lshl_b32 s86, s86, 7
    s_mov_b32 s87, 0x20000
    v_lshlrev_b32 v220, 7, v1
    s_and_b32 s55, s2, 7
    s_lshl_b32 s55, s55, 2
    s_lshr_b32 s56, s2, 6
    s_add_u32 s55, s55, s56
    s_lshl_b32 s55, s55, 7
    s_add_u32 s55, s55, 53248
    s_min_u32 s56, s3, 2
    s_lshl_b32 s56, s56, 12
    s_add_u32 s55, s55, s56
    v_mov_b32 v177, 0
    buffer_load_dword v176, v177, s[32:35], s55 offen
    s_bitcmp1_b32 s37, 0
    s_cbranch_scc1 L_typeB
    s_add_u32 m0, s50, 40960
    s_mul_i32 s54, s77, 1536
    buffer_load_dwordx4 v8, s[4:7], s77 offen lds
    buffer_load_dwordx4 v9, s[4:7], s77 offen offset:1024 lds
    s_mov_b32 s63, s62
    v_cmp_eq_u32 vcc, 0, v1
    v_mov_b32 v222, 2147418112
    v_mov_b32 v166, 0
    v_cndmask_b32 v5, v222, 0, vcc
    s_sub_u32 s56, s3, 3
    s_lshr_b32 s57, s36, 1
    s_or_b32 s56, s56, s57
    s_cmp_eq_u32 s56, 0
    s_cselect_b32 s56, 0, 2147418112
    s_lshl_b32 s55, s38, 1
    s_add_u32 s55, s55, s36
    s_lshl_b32 s57, s55, 12
    s_add_u32 s57, s57, s56
    v_add_u32 v194, s57, v2
    s_lshl_b32 s57, s55, 7
    s_add_u32 s57, s57, s56
    v_add_u32 v195, s57, v5
    v_min_u32 v195, 2147418112, v195
    v_mov_b32 v196, 0
    v_mov_b32 v197, 0
    v_mov_b32 v198, 0
    v_mov_b32 v199, 0
    s_mov_b32 s27, 0x20000
    s_lshl_b32 s51, s3, 11
    s_add_u32 s51, s51, 98304
    s_and_b32 s91, s36, 1
    s_lshl_b32 s90, s91, 15
    s_lshl_b32 s91, s91, 9
    s_lshl_b32 s52, s3, 10
    v_mul_u32_u24 v222, 3072, v239
    s_lshl_b32 s55, s38, 7
    v_add3_u32 v16, v222, v242, s55
    v_add_u32 v17, 23552, v16
    s_lshl_b32 s55, s39, 11
    s_add_u32 s56, s55, 98304
    s_sub_u32 s57, 100352, s55
    v_add_u32 v30, s56, v237
    v_add_u32 v31, s57, v237
    s_lshl_b32 s55, s38, 1
    s_add_u32 s55, s55, s40
    s_lshl_b32 s56, s36, 1
    s_add_u32 s56, s56, s39
    s_lshl_b32 s62, s56, 9
    s_add_u32 s62, s62, 4096
    v_lshlrev_b32 v178, 1, v167
    s_lshl_b32 s57, s55, 7
    s_add_u32 s74, s57, 32768
    s_add_u32 s67, s57, 36864
    s_lshl_b32 s71, s55, 12
    s_add_u32 s71, s71, 65536
    s_lshl_b32 s57, s56, 2
    s_add_u32 s64, s67, s57
    s_lshl_b32 s59, s56, 18
    s_add_u32 s59, s59, 1048576
    s_lshl_b32 s56, s56, 5
    s_add_u32 s56, s56, s55
    s_lshl_b32 s56, s56, 2
    s_add_u32 s65, s56, 45056
    s_add_u32 s75, s56, 40960
    s_add_u32 s66, s56, 49152
    s_and_b32 s42, s2, 7
    s_lshl_b32 s42, s42, 2
    s_lshr_b32 s55, s2, 6
    s_add_u32 s42, s42, s55
    s_lshr_b32 s43, s2, 3
    s_and_b32 s43, s43, 7
    s_xor_b32 s43, s43, 4
    s_lshl_b32 s55, s3, 3
    v_add_lshl_u32 v222, s55, v240, 10
    s_lshl_b32 s55, s43, 7
    v_add3_u32 v6, v222, v242, s55
    v_cmp_gt_u32 vcc, 32, v1
    v_mov_b32 v187, 0x3fb8aa3b
    v_lshlrev_b32 v3, 2, v1
    v_cndmask_b32 v4, 0, -1, vcc
    v_mov_b32 v186, 0x358637bd
    v_mov_b32 v188, 0xb5c1a2a0
    v_mov_b32 v184, 0xbfb17218
    v_mov_b32 v185, 0x3f317218
    v_mov_b32 v170, 0
    v_mov_b32 v171, 0
    v_mov_b32 v174, 0
    v_mov_b32 v175, 0
    v_mov_b32 v248, 0
    v_mov_b32 v249, 0
    v_mov_b32 v252, 0
    v_mov_b32 v253, 0
    v_mov_b32 v247, 0
    v_mov_b32 v251, 0
    v_and_b32 v222, 16, v1
    v_cmp_eq_u32 s[46:47], 0, v222
    s_lshl_b32 s55, s3, 9
    v_add_u32 v254, s55, v3
    v_xor_b32 v255, 512, v254
    s_lshr_b32 s55, s2, 3
    s_mul_i32 s56, s55, 43
    s_mul_i32 s57, s3, 22
    s_add_u32 s56, s56, s57
    s_lshl_b32 s57, s55, 4
    s_cmp_ge_u32 s3, 2
    s_cselect_b32 s56, s57, s56
    s_cselect_b32 s92, s16, s20
    s_cselect_b32 s93, s17, s21
    s_lshl_b32 s56, s56, 10
    s_add_u32 s56, s56, 384
    s_add_u32 s92, s92, s56
    s_addc_u32 s93, s93, 0
    s_lshl_b32 s57, s3, 3
    s_lshr_b32 s94, 1053974, s57
    s_and_b32 s94, s94, 0xff
    s_lshl_b32 s94, s94, 10
    s_sub_u32 s94, s94, 512
    s_max_i32 s94, s94, 0
    s_mov_b32 s95, 0x20000
    v_lshlrev_b32 v177, 10, v1
    s_waitcnt vmcnt(7)
    v_dot2_f32_bf16 v200, v224, v189, 0
    buffer_load_dwordx4 v10, s[4:7], s77 offen offset:2048 lds
    v_dot2_f32_bf16 v202, v224, v224, 0
    v_dot2_f32_bf16 v201, v228, v189, 0
    v_dot2_f32_bf16 v203, v228, v228, 0
    v_dot2_f32_bf16 v200, v225, v189, v200
    v_dot2_f32_bf16 v202, v225, v225, v202
    v_dot2_f32_bf16 v201, v229, v189, v201
    v_dot2_f32_bf16 v203, v229, v229, v203
    v_dot2_f32_bf16 v200, v226, v189, v200
    v_dot2_f32_bf16 v202, v226, v226, v202
    v_dot2_f32_bf16 v201, v230, v189, v201
    buffer_load_dwordx4 v11, s[4:7], s77 offen offset:3072 lds
    s_add_u32 m0, s50, 45056
    v_dot2_f32_bf16 v203, v230, v230, v203
    v_dot2_f32_bf16 v200, v227, v189, v200
    v_dot2_f32_bf16 v202, v227, v227, v202
    v_dot2_f32_bf16 v201, v231, v189, v201
    v_dot2_f32_bf16 v203, v231, v231, v203
    s_nop 2
    v_add_f32_dpp v200, v200, v200 row_ror:8 row_mask:0xf bank_mask:0xf
    v_add_f32_dpp v201, v201, v201 row_ror:8 row_mask:0xf bank_mask:0xf
    v_add_f32_dpp v202, v202, v202 row_ror:8 row_mask:0xf bank_mask:0xf
    buffer_load_dwordx4 v12, s[8:11], s54 offen lds
    v_add_f32_dpp v203, v203, v203 row_ror:8 row_mask:0xf bank_mask:0xf
    v_add_f32_dpp v200, v200, v200 row_ror:4 row_mask:0xf bank_mask:0xf
    v_add_f32_dpp v201, v201, v201 row_ror:4 row_mask:0xf bank_mask:0xf
    v_add_f32_dpp v202, v202, v202 row_ror:4 row_mask:0xf bank_mask:0xf
    v_add_f32_dpp v203, v203, v203 row_ror:4 row_mask:0xf bank_mask:0xf
    v_add_f32_dpp v200, v200, v200 row_ror:2 row_mask:0xf bank_mask:0xf
    v_add_f32_dpp v201, v201, v201 row_ror:2 row_mask:0xf bank_mask:0xf
    v_add_f32_dpp v202, v202, v202 row_ror:2 row_mask:0xf bank_mask:0xf
    v_add_f32_dpp v203, v203, v203 row_ror:2 row_mask:0xf bank_mask:0xf
    v_add_f32_dpp v200, v200, v200 row_ror:1 row_mask:0xf bank_mask:0xf
    buffer_load_dwordx4 v13, s[8:11], s54 offen offset:1024 lds
    s_add_u32 m0, s50, 47104
    v_add_f32_dpp v201, v201, v201 row_ror:1 row_mask:0xf bank_mask:0xf
    v_add_f32_dpp v202, v202, v202 row_ror:1 row_mask:0xf bank_mask:0xf
    v_add_f32_dpp v203, v203, v203 row_ror:1 row_mask:0xf bank_mask:0xf
    v_add_f32_dpp v200, v200, v200 row_bcast:15 row_mask:0xa bank_mask:0xf
    v_add_f32_dpp v201, v201, v201 row_bcast:15 row_mask:0xa bank_mask:0xf
    v_add_f32_dpp v202, v202, v202 row_bcast:15 row_mask:0xa bank_mask:0xf
    v_add_f32_dpp v203, v203, v203 row_bcast:15 row_mask:0xa bank_mask:0xf
    v_add_f32_dpp v200, v200, v200 row_bcast:31 row_mask:0xc bank_mask:0xf
    v_add_f32_dpp v201, v201, v201 row_bcast:31 row_mask:0xc bank_mask:0xf
    buffer_load_dwordx4 v14, s[8:11], s54 offen lds
    v_add_f32_dpp v202, v202, v202 row_bcast:31 row_mask:0xc bank_mask:0xf
    v_add_f32_dpp v203, v203, v203 row_bcast:31 row_mask:0xc bank_mask:0xf
    v_mul_f32 v200, 0x3b000000, v200
    v_mul_f32 v201, 0x3b000000, v201
    v_mul_f32 v202, 0x3b000000, v202
    v_mul_f32 v203, 0x3b000000, v203
    v_fma_f32 v202, -v200, v200, v202
    v_fma_f32 v203, -v201, v201, v203
    v_max_f32 v202, 0, v202
    v_max_f32 v203, 0, v203
    buffer_load_dwordx4 v15, s[8:11], s54 offen offset:1024 lds
    v_cvt_pk_bf16_f32 v204, v202, v203
    v_lshlrev_b32 v205, 16, v204
    v_and_b32 v206, 0xffff0000, v204
    v_add_f32 v205, 0x3727c5ac, v205
    v_add_f32 v206, 0x3727c5ac, v206
    v_cvt_pk_bf16_f32 v204, v205, v206
    v_lshlrev_b32 v205, 16, v204
    v_and_b32 v206, 0xffff0000, v204
    v_sqrt_f32 v205, v205
    v_sqrt_f32 v206, v206
    s_waitcnt lgkmcnt(0)
    s_add_u32 s41, s61, 1540483477
    v_mov_b32 v7, s41
    v_mov_b32 v209, s41
    v_mov_b32 v211, s41
    v_cvt_pk_bf16_f32 v208, v200, v205
    v_cvt_pk_bf16_f32 v210, v201, v206
    buffer_store_dwordx4 v[208:211], v212, s[32:35], s63 offen sc1
    s_waitcnt vmcnt(10)
    s_barrier
    ds_read_b64_tr_b16 v[48:49], v26 offset:0
    ds_read_b64_tr_b16 v[50:51], v26 offset:512
    ds_read_b128 a[0:3], v18 offset:0
    ds_read_b128 a[4:7], v18 offset:8192
    ds_read_b64_tr_b16 v[52:53], v26 offset:2048
    ds_read_b64_tr_b16 v[54:55], v26 offset:2560
    s_waitcnt lgkmcnt(3)
    v_mfma_f32_32x32x16_bf16 v[64:79], a[0:3], v[48:51], 0
    ds_read_b64_tr_b16 v[56:57], v27 offset:0
    ds_read_b64_tr_b16 v[58:59], v27 offset:512
    ds_read_b128 a[8:11], v19 offset:0
    buffer_load_dword v176, v220, s[84:87], 0 offen
    s_add_u32 m0, s50, 73728
    s_mul_i32 s54, s78, 1536
    s_waitcnt lgkmcnt(5)
    v_mfma_f32_32x32x16_bf16 v[80:95], a[4:7], v[48:51], 0
    buffer_load_dwordx4 v8, s[4:7], s78 offen lds
    v_dot2_f32_bf16 v46, v48, v189, 0
    v_dot2_f32_bf16 v46, v49, v189, v46
    s_waitcnt lgkmcnt(3)
    v_mfma_f32_32x32x16_bf16 v[96:111], a[0:3], v[52:55], 0
    ds_read_b128 a[12:15], v19 offset:8192
    ds_read_b64_tr_b16 v[60:61], v27 offset:2048
    ds_read_b64_tr_b16 v[62:63], v27 offset:2560
    buffer_load_dwordx4 v9, s[4:7], s78 offen offset:1024 lds
    v_mfma_f32_32x32x16_bf16 v[112:127], a[4:7], v[52:55], 0
    buffer_load_dwordx4 v10, s[4:7], s78 offen offset:2048 lds
    v_dot2_f32_bf16 v47, v52, v189, 0
    v_dot2_f32_bf16 v47, v53, v189, v47
    s_waitcnt lgkmcnt(3)
    v_mfma_f32_32x32x16_bf16 v[64:79], a[8:11], v[56:59], v[64:79]
    ds_read_b64_tr_b16 v[48:49], v26 offset:16384
    ds_read_b64_tr_b16 v[50:51], v26 offset:16896
    ds_read_b128 a[16:19], v20 offset:0
    buffer_load_dwordx4 v11, s[4:7], s78 offen offset:3072 lds
    s_add_u32 m0, s50, 77824
    s_waitcnt lgkmcnt(5)
    v_mfma_f32_32x32x16_bf16 v[80:95], a[12:15], v[56:59], v[80:95]
    buffer_load_dwordx4 v12, s[8:11], s54 offen lds
    v_dot2_f32_bf16 v46, v58, v189, v46
    v_dot2_f32_bf16 v46, v59, v189, v46
    s_waitcnt lgkmcnt(3)
    v_mfma_f32_32x32x16_bf16 v[96:111], a[8:11], v[60:63], v[96:111]
    ds_read_b128 a[20:23], v20 offset:8192
    ds_read_b64_tr_b16 v[52:53], v26 offset:18432
    ds_read_b64_tr_b16 v[54:55], v26 offset:18944
    buffer_load_dwordx4 v13, s[8:11], s54 offen offset:1024 lds
    s_add_u32 m0, s50, 79872
    v_mfma_f32_32x32x16_bf16 v[112:127], a[12:15], v[60:63], v[112:127]
    buffer_load_dwordx4 v14, s[8:11], s54 offen lds
    v_dot2_f32_bf16 v47, v62, v189, v47
    v_dot2_f32_bf16 v47, v63, v189, v47
    s_waitcnt lgkmcnt(3)
    v_mfma_f32_32x32x16_bf16 v[64:79], a[16:19], v[48:51], v[64:79]
    ds_read_b64_tr_b16 v[56:57], v27 offset:16384
    ds_read_b64_tr_b16 v[58:59], v27 offset:16896
    ds_read_b128 a[24:27], v21 offset:0
    buffer_load_dwordx4 v15, s[8:11], s54 offen offset:1024 lds
    s_waitcnt lgkmcnt(5)
    v_mfma_f32_32x32x16_bf16 v[80:95], a[20:23], v[48:51], v[80:95]
    s_mov_b32 s73, 65536
    buffer_store_dwordx4 v[196:199], v194, s[32:35], s73 offen offset:0 sc1
    buffer_store_dwordx4 v[196:199], v194, s[32:35], s73 offen offset:1024 sc1
    buffer_store_dwordx4 v[196:199], v194, s[32:35], s73 offen offset:2048 sc1
    v_dot2_f32_bf16 v46, v48, v189, v46
    v_dot2_f32_bf16 v46, v49, v189, v46
    s_waitcnt lgkmcnt(3)
    v_mfma_f32_32x32x16_bf16 v[96:111], a[16:19], v[52:55], v[96:111]
    ds_read_b128 a[28:31], v21 offset:8192
    ds_read_b64_tr_b16 v[60:61], v27 offset:18432
    ds_read_b64_tr_b16 v[62:63], v27 offset:18944
    v_mfma_f32_32x32x16_bf16 v[112:127], a[20:23], v[52:55], v[112:127]
    v_dot2_f32_bf16 v47, v52, v189, v47
    v_dot2_f32_bf16 v47, v53, v189, v47
    s_waitcnt lgkmcnt(0)
    s_waitcnt vmcnt(13)
    s_barrier
    v_mfma_f32_32x32x16_bf16 v[64:79], a[24:27], v[56:59], v[64:79]
    ds_read_b64_tr_b16 v[48:49], v26 offset:32768
    ds_read_b64_tr_b16 v[50:51], v26 offset:33280
    ds_read_b128 a[32:35], v18 offset:32768
    v_mfma_f32_32x32x16_bf16 v[80:95], a[28:31], v[56:59], v[80:95]
    s_add_u32 m0, s50, 8192
    s_mul_i32 s54, s79, 1536
    buffer_load_dwordx4 v8, s[4:7], s79 offen lds
    v_dot2_f32_bf16 v46, v58, v189, v46
    v_dot2_f32_bf16 v46, v59, v189, v46
    v_mfma_f32_32x32x16_bf16 v[96:111], a[24:27], v[60:63], v[96:111]
    ds_read_b128 a[36:39], v18 offset:40960
    ds_read_b64_tr_b16 v[52:53], v26 offset:34816
    ds_read_b64_tr_b16 v[54:55], v26 offset:35328
    v_mfma_f32_32x32x16_bf16 v[112:127], a[28:31], v[60:63], v[112:127]
    buffer_load_dwordx4 v9, s[4:7], s79 offen offset:1024 lds
    v_dot2_f32_bf16 v47, v62, v189, v47
    v_dot2_f32_bf16 v47, v63, v189, v47
    s_waitcnt lgkmcnt(3)
    v_mfma_f32_32x32x16_bf16 v[64:79], a[32:35], v[48:51], v[64:79]
    ds_read_b64_tr_b16 v[56:57], v27 offset:32768
    ds_read_b64_tr_b16 v[58:59], v27 offset:33280
    ds_read_b128 a[40:43], v19 offset:32768
    s_waitcnt lgkmcnt(5)
    v_mfma_f32_32x32x16_bf16 v[80:95], a[36:39], v[48:51], v[80:95]
    buffer_load_dwordx4 v10, s[4:7], s79 offen offset:2048 lds
    v_dot2_f32_bf16 v46, v48, v189, v46
    v_dot2_f32_bf16 v46, v49, v189, v46
    s_waitcnt lgkmcnt(3)
    v_mfma_f32_32x32x16_bf16 v[96:111], a[32:35], v[52:55], v[96:111]
    ds_read_b128 a[44:47], v19 offset:40960
    ds_read_b64_tr_b16 v[60:61], v27 offset:34816
    ds_read_b64_tr_b16 v[62:63], v27 offset:35328
    buffer_load_dwordx4 v11, s[4:7], s79 offen offset:3072 lds
    s_add_u32 m0, s50, 12288
    v_mfma_f32_32x32x16_bf16 v[112:127], a[36:39], v[52:55], v[112:127]
    buffer_load_dwordx4 v12, s[8:11], s54 offen lds
    v_dot2_f32_bf16 v47, v52, v189, v47
    v_dot2_f32_bf16 v47, v53, v189, v47
    s_waitcnt lgkmcnt(3)
    v_mfma_f32_32x32x16_bf16 v[64:79], a[40:43], v[56:59], v[64:79]
    ds_read_b64_tr_b16 v[48:49], v26 offset:49152
    ds_read_b64_tr_b16 v[50:51], v26 offset:49664
    ds_read_b128 a[48:51], v20 offset:32768
    s_waitcnt lgkmcnt(5)
    v_mfma_f32_32x32x16_bf16 v[80:95], a[44:47], v[56:59], v[80:95]
    buffer_load_dwordx4 v13, s[8:11], s54 offen offset:1024 lds
    s_add_u32 m0, s50, 14336
    v_dot2_f32_bf16 v46, v58, v189, v46
    v_dot2_f32_bf16 v46, v59, v189, v46
    s_waitcnt lgkmcnt(3)
    v_mfma_f32_32x32x16_bf16 v[96:111], a[40:43], v[60:63], v[96:111]
    ds_read_b128 a[52:55], v20 offset:40960
    ds_read_b64_tr_b16 v[52:53], v26 offset:51200
    ds_read_b64_tr_b16 v[54:55], v26 offset:51712
    v_mfma_f32_32x32x16_bf16 v[112:127], a[44:47], v[60:63], v[112:127]
    buffer_load_dwordx4 v14, s[8:11], s54 offen lds
    v_dot2_f32_bf16 v47, v62, v189, v47
    v_dot2_f32_bf16 v47, v63, v189, v47
    s_waitcnt lgkmcnt(3)
    v_mfma_f32_32x32x16_bf16 v[64:79], a[48:51], v[48:51], v[64:79]
    ds_read_b64_tr_b16 v[56:57], v27 offset:49152
    ds_read_b64_tr_b16 v[58:59], v27 offset:49664
    ds_read_b128 a[56:59], v21 offset:32768
    s_waitcnt lgkmcnt(5)
    v_mfma_f32_32x32x16_bf16 v[80:95], a[52:55], v[48:51], v[80:95]
    buffer_load_dwordx4 v15, s[8:11], s54 offen offset:1024 lds
    s_add_u32 m0, s51, 8192
    s_mul_i32 s54, s45, 1536
    v_dot2_f32_bf16 v46, v48, v189, v46
    v_dot2_f32_bf16 v46, v49, v189, v46
    s_waitcnt lgkmcnt(3)
    v_mfma_f32_32x32x16_bf16 v[96:111], a[48:51], v[52:55], v[96:111]
    ds_read_b128 a[60:63], v21 offset:40960
    ds_read_b64_tr_b16 v[60:61], v27 offset:51200
    ds_read_b64_tr_b16 v[62:63], v27 offset:51712
    buffer_load_dwordx4 v16, s[8:11], s54 offen lds
    v_mfma_f32_32x32x16_bf16 v[112:127], a[52:55], v[52:55], v[112:127]
    buffer_load_dwordx4 v17, s[8:11], s54 offen offset:1024 lds
    v_dot2_f32_bf16 v47, v52, v189, v47
    v_dot2_f32_bf16 v47, v53, v189, v47
    s_waitcnt lgkmcnt(0)
    s_waitcnt vmcnt(13)
    s_barrier
    v_mfma_f32_32x32x16_bf16 v[64:79], a[56:59], v[56:59], v[64:79]
    ds_read_b64_tr_b16 v[48:49], v28 offset:0
    ds_read_b64_tr_b16 v[50:51], v28 offset:512
    ds_read_b128 a[64:67], v22 offset:0
    v_mfma_f32_32x32x16_bf16 v[80:95], a[60:63], v[56:59], v[80:95]
    s_waitcnt vmcnt(10)
    s_mov_b32 s73, 32768
    buffer_store_dword v7, v195, s[32:35], s73 offen sc1
    s_add_u32 m0, s50, 40960
    s_mul_i32 s54, s80, 1536
    v_dot2_f32_bf16 v46, v58, v189, v46
    v_dot2_f32_bf16 v46, v59, v189, v46
    v_mfma_f32_32x32x16_bf16 v[96:111], a[56:59], v[60:63], v[96:111]
    ds_read_b128 a[68:71], v22 offset:8192
    ds_read_b64_tr_b16 v[52:53], v28 offset:2048
    ds_read_b64_tr_b16 v[54:55], v28 offset:2560
    v_mfma_f32_32x32x16_bf16 v[112:127], a[60:63], v[60:63], v[112:127]
    buffer_load_dwordx4 v8, s[4:7], s80 offen lds
    v_dot2_f32_bf16 v47, v62, v189, v47
    v_dot2_f32_bf16 v47, v63, v189, v47
    s_waitcnt lgkmcnt(3)
    v_mfma_f32_32x32x16_bf16 v[64:79], a[64:67], v[48:51], v[64:79]
    ds_read_b64_tr_b16 v[56:57], v29 offset:0
    ds_read_b64_tr_b16 v[58:59], v29 offset:512
    ds_read_b128 a[72:75], v23 offset:0
    s_waitcnt lgkmcnt(5)
    v_mfma_f32_32x32x16_bf16 v[80:95], a[68:71], v[48:51], v[80:95]
    buffer_load_dwordx4 v9, s[4:7], s80 offen offset:1024 lds
    v_dot2_f32_bf16 v46, v48, v189, v46
    v_dot2_f32_bf16 v46, v49, v189, v46
    s_waitcnt lgkmcnt(3)
    v_mfma_f32_32x32x16_bf16 v[96:111], a[64:67], v[52:55], v[96:111]
    ds_read_b128 a[76:79], v23 offset:8192
    ds_read_b64_tr_b16 v[60:61], v29 offset:2048
    ds_read_b64_tr_b16 v[62:63], v29 offset:2560
    buffer_load_dwordx4 v10, s[4:7], s80 offen offset:2048 lds
    v_mfma_f32_32x32x16_bf16 v[112:127], a[68:71], v[52:55], v[112:127]
    buffer_load_dwordx4 v11, s[4:7], s80 offen offset:3072 lds
    s_add_u32 m0, s50, 45056
    v_dot2_f32_bf16 v47, v52, v189, v47
    v_dot2_f32_bf16 v47, v53, v189, v47
    s_waitcnt lgkmcnt(3)
    v_mfma_f32_32x32x16_bf16 v[64:79], a[72:75], v[56:59], v[64:79]
    ds_read_b64_tr_b16 v[48:49], v28 offset:16384
    ds_read_b64_tr_b16 v[50:51], v28 offset:16896
    ds_read_b128 a[80:83], v24 offset:0
    s_waitcnt lgkmcnt(5)
    v_mfma_f32_32x32x16_bf16 v[80:95], a[76:79], v[56:59], v[80:95]
    buffer_load_dwordx4 v12, s[8:11], s54 offen lds
    v_dot2_f32_bf16 v46, v58, v189, v46
    v_dot2_f32_bf16 v46, v59, v189, v46
    s_waitcnt lgkmcnt(3)
    v_mfma_f32_32x32x16_bf16 v[96:111], a[72:75], v[60:63], v[96:111]
    ds_read_b128 a[84:87], v24 offset:8192
    ds_read_b64_tr_b16 v[52:53], v28 offset:18432
    ds_read_b64_tr_b16 v[54:55], v28 offset:18944
    v_mfma_f32_32x32x16_bf16 v[112:127], a[76:79], v[60:63], v[112:127]
    buffer_load_dwordx4 v13, s[8:11], s54 offen offset:1024 lds
    s_add_u32 m0, s50, 47104
    v_dot2_f32_bf16 v47, v62, v189, v47
    v_dot2_f32_bf16 v47, v63, v189, v47
    s_waitcnt lgkmcnt(3)
    v_mfma_f32_32x32x16_bf16 v[64:79], a[80:83], v[48:51], v[64:79]
    ds_read_b64_tr_b16 v[56:57], v29 offset:16384
    ds_read_b64_tr_b16 v[58:59], v29 offset:16896
    ds_read_b128 a[88:91], v25 offset:0
    s_waitcnt lgkmcnt(5)
    v_mfma_f32_32x32x16_bf16 v[80:95], a[84:87], v[48:51], v[80:95]
    buffer_load_dwordx4 v14, s[8:11], s54 offen lds
    v_dot2_f32_bf16 v46, v48, v189, v46
    v_dot2_f32_bf16 v46, v49, v189, v46
    s_waitcnt lgkmcnt(3)
    v_mfma_f32_32x32x16_bf16 v[96:111], a[80:83], v[52:55], v[96:111]
    ds_read_b128 a[92:95], v25 offset:8192
    ds_read_b64_tr_b16 v[60:61], v29 offset:18432
    ds_read_b64_tr_b16 v[62:63], v29 offset:18944
    buffer_load_dwordx4 v15, s[8:11], s54 offen offset:1024 lds
    s_add_u32 m0, s51, 16384
    s_mul_i32 s54, s77, 1536
    v_mfma_f32_32x32x16_bf16 v[112:127], a[84:87], v[52:55], v[112:127]
    buffer_load_dwordx4 v16, s[8:11], s54 offen lds
    v_dot2_f32_bf16 v47, v52, v189, v47
    v_dot2_f32_bf16 v47, v53, v189, v47
    s_waitcnt lgkmcnt(0)
    s_waitcnt vmcnt(12)
    s_barrier
    v_mfma_f32_32x32x16_bf16 v[64:79], a[88:91], v[56:59], v[64:79]
    ds_read_b64_tr_b16 v[48:49], v26 offset:0
    ds_read_b64_tr_b16 v[50:51], v26 offset:512
    ds_read_b128 a[96:99], v18 offset:0
    v_mfma_f32_32x32x16_bf16 v[80:95], a[92:95], v[56:59], v[80:95]
    buffer_load_dwordx4 v17, s[8:11], s54 offen offset:1024 lds
    s_add_u32 m0, s50, 73728
    s_mul_i32 s54, s81, 1536
    v_dot2_f32_bf16 v46, v58, v189, v46
    v_dot2_f32_bf16 v46, v59, v189, v46
    v_mfma_f32_32x32x16_bf16 v[96:111], a[88:91], v[60:63], v[96:111]
    ds_read_b128 a[100:103], v18 offset:8192
    ds_read_b64_tr_b16 v[52:53], v26 offset:2048
    ds_read_b64_tr_b16 v[54:55], v26 offset:2560
    v_mfma_f32_32x32x16_bf16 v[112:127], a[92:95], v[60:63], v[112:127]
    buffer_load_dwordx4 v8, s[4:7], s81 offen lds
    v_dot2_f32_bf16 v47, v62, v189, v47
    v_dot2_f32_bf16 v47, v63, v189, v47
    s_waitcnt lgkmcnt(3)
    v_mfma_f32_32x32x16_bf16 v[64:79], a[96:99], v[48:51], v[64:79]
    ds_read_b64_tr_b16 v[56:57], v27 offset:0
    ds_read_b64_tr_b16 v[58:59], v27 offset:512
    ds_read_b128 a[104:107], v19 offset:0
    s_waitcnt lgkmcnt(5)
    v_mfma_f32_32x32x16_bf16 v[80:95], a[100:103], v[48:51], v[80:95]
    buffer_load_dwordx4 v9, s[4:7], s81 offen offset:1024 lds
    v_dot2_f32_bf16 v46, v48, v189, v46
    v_dot2_f32_bf16 v46, v49, v189, v46
    s_waitcnt lgkmcnt(3)
    v_mfma_f32_32x32x16_bf16 v[96:111], a[96:99], v[52:55], v[96:111]
    ds_read_b128 a[108:111], v19 offset:8192
    ds_read_b64_tr_b16 v[60:61], v27 offset:2048
    ds_read_b64_tr_b16 v[62:63], v27 offset:2560
    buffer_load_dwordx4 v10, s[4:7], s81 offen offset:2048 lds
    v_mfma_f32_32x32x16_bf16 v[112:127], a[100:103], v[52:55], v[112:127]
    buffer_load_dwordx4 v11, s[4:7], s81 offen offset:3072 lds
    s_add_u32 m0, s50, 77824
    v_dot2_f32_bf16 v47, v52, v189, v47
    v_dot2_f32_bf16 v47, v53, v189, v47
    s_waitcnt lgkmcnt(3)
    v_mfma_f32_32x32x16_bf16 v[64:79], a[104:107], v[56:59], v[64:79]
    ds_read_b64_tr_b16 v[48:49], v26 offset:16384
    ds_read_b64_tr_b16 v[50:51], v26 offset:16896
    ds_read_b128 a[112:115], v20 offset:0
    s_waitcnt lgkmcnt(5)
    v_mfma_f32_32x32x16_bf16 v[80:95], a[108:111], v[56:59], v[80:95]
    buffer_load_dwordx4 v12, s[8:11], s54 offen lds
    v_dot2_f32_bf16 v46, v58, v189, v46
    v_dot2_f32_bf16 v46, v59, v189, v46
    s_waitcnt lgkmcnt(3)
    v_mfma_f32_32x32x16_bf16 v[96:111], a[104:107], v[60:63], v[96:111]
    ds_read_b128 a[116:119], v20 offset:8192
    ds_read_b64_tr_b16 v[52:53], v26 offset:18432
    ds_read_b64_tr_b16 v[54:55], v26 offset:18944
    v_mfma_f32_32x32x16_bf16 v[112:127], a[108:111], v[60:63], v[112:127]
    buffer_load_dwordx4 v13, s[8:11], s54 offen offset:1024 lds
    s_add_u32 m0, s50, 79872
    v_dot2_f32_bf16 v47, v62, v189, v47
    v_dot2_f32_bf16 v47, v63, v189, v47
    s_waitcnt lgkmcnt(3)
    v_mfma_f32_32x32x16_bf16 v[64:79], a[112:115], v[48:51], v[64:79]
    ds_read_b64_tr_b16 v[56:57], v27 offset:16384
    ds_read_b64_tr_b16 v[58:59], v27 offset:16896
    ds_read_b128 a[120:123], v21 offset:0
    s_waitcnt lgkmcnt(5)
    v_mfma_f32_32x32x16_bf16 v[80:95], a[116:119], v[48:51], v[80:95]
    buffer_load_dwordx4 v14, s[8:11], s54 offen lds
    v_dot2_f32_bf16 v46, v48, v189, v46
    v_dot2_f32_bf16 v46, v49, v189, v46
    s_waitcnt lgkmcnt(3)
    v_mfma_f32_32x32x16_bf16 v[96:111], a[112:115], v[52:55], v[96:111]
    ds_read_b128 a[124:127], v21 offset:8192
    ds_read_b64_tr_b16 v[60:61], v27 offset:18432
    ds_read_b64_tr_b16 v[62:63], v27 offset:18944
    buffer_load_dwordx4 v15, s[8:11], s54 offen offset:1024 lds
    s_add_u32 m0, s51, 24576
    s_mul_i32 s54, s78, 1536
    v_mfma_f32_32x32x16_bf16 v[112:127], a[116:119], v[52:55], v[112:127]
    buffer_load_dwordx4 v16, s[8:11], s54 offen lds
    v_dot2_f32_bf16 v47, v52, v189, v47
    v_dot2_f32_bf16 v47, v53, v189, v47
    s_waitcnt lgkmcnt(0)
    s_waitcnt vmcnt(11)
    s_barrier
    v_mfma_f32_32x32x16_bf16 v[64:79], a[120:123], v[56:59], v[64:79]
    ds_read_b64_tr_b16 v[48:49], v26 offset:32768
    ds_read_b64_tr_b16 v[50:51], v26 offset:33280
    ds_read_b128 a[128:131], v18 offset:32768
    v_mfma_f32_32x32x16_bf16 v[80:95], a[124:127], v[56:59], v[80:95]
    buffer_load_dwordx4 v17, s[8:11], s54 offen offset:1024 lds
    v_dot2_f32_bf16 v46, v58, v189, v46
    v_dot2_f32_bf16 v46, v59, v189, v46
    v_mfma_f32_32x32x16_bf16 v[96:111], a[120:123], v[60:63], v[96:111]
    ds_read_b128 a[132:135], v18 offset:40960
    ds_read_b64_tr_b16 v[52:53], v26 offset:34816
    ds_read_b64_tr_b16 v[54:55], v26 offset:35328
    buffer_load_dwordx2 v[160:161], v178, s[32:35], s62 offen sc1
    buffer_load_dwordx2 v[162:163], v178, s[32:35], s62 offen offset:256 sc1
    buffer_load_dword v164, v166, s[32:35], s74 offen sc1
    s_add_u32 m0, s50, 8192
    s_mul_i32 s54, s82, 1536
    v_mfma_f32_32x32x16_bf16 v[112:127], a[124:127], v[60:63], v[112:127]
    buffer_load_dwordx4 v8, s[4:7], s82 offen lds
    v_dot2_f32_bf16 v47, v62, v189, v47
    v_dot2_f32_bf16 v47, v63, v189, v47
    s_waitcnt lgkmcnt(3)
    v_mfma_f32_32x32x16_bf16 v[64:79], a[128:131], v[48:51], v[64:79]
    ds_read_b64_tr_b16 v[56:57], v27 offset:32768
    ds_read_b64_tr_b16 v[58:59], v27 offset:33280
    ds_read_b128 a[136:139], v19 offset:32768
    s_waitcnt lgkmcnt(5)
    v_mfma_f32_32x32x16_bf16 v[80:95], a[132:135], v[48:51], v[80:95]
    buffer_load_dwordx4 v9, s[4:7], s82 offen offset:1024 lds
    s_waitcnt lgkmcnt(3)
    v_mfma_f32_32x32x16_bf16 v[96:111], a[128:131], v[52:55], v[96:111]
    ds_read_b128 a[140:143], v19 offset:40960
    ds_read_b64_tr_b16 v[60:61], v27 offset:34816
    ds_read_b64_tr_b16 v[62:63], v27 offset:35328
    v_mfma_f32_32x32x16_bf16 v[112:127], a[132:135], v[52:55], v[112:127]
    buffer_load_dwordx4 v10, s[4:7], s82 offen offset:2048 lds
    v_dot2_f32_bf16 v46, v48, v189, v46
    v_dot2_f32_bf16 v47, v52, v189, v47
    v_dot2_f32_bf16 v46, v49, v189, v46
    v_dot2_f32_bf16 v47, v53, v189, v47
    v_dot2_f32_bf16 v46, v50, v189, v46
    v_dot2_f32_bf16 v47, v54, v189, v47
    v_dot2_f32_bf16 v46, v51, v189, v46
    v_dot2_f32_bf16 v47, v55, v189, v47
    s_waitcnt lgkmcnt(3)
    v_mfma_f32_32x32x16_bf16 v[64:79], a[136:139], v[56:59], v[64:79]
    ds_read_b64_tr_b16 v[48:49], v26 offset:49152
    ds_read_b64_tr_b16 v[50:51], v26 offset:49664
    ds_read_b128 a[144:147], v20 offset:32768
    s_waitcnt lgkmcnt(5)
    v_mfma_f32_32x32x16_bf16 v[80:95], a[140:143], v[56:59], v[80:95]
    buffer_load_dwordx4 v11, s[4:7], s82 offen offset:3072 lds
    s_add_u32 m0, s50, 12288
    s_waitcnt lgkmcnt(3)
    v_mfma_f32_32x32x16_bf16 v[96:111], a[136:139], v[60:63], v[96:111]
    ds_read_b128 a[148:151], v20 offset:40960
    ds_read_b64_tr_b16 v[52:53], v26 offset:51200
    ds_read_b64_tr_b16 v[54:55], v26 offset:51712
    v_mfma_f32_32x32x16_bf16 v[112:127], a[140:143], v[60:63], v[112:127]
    buffer_load_dwordx4 v12, s[8:11], s54 offen lds
    s_waitcnt lgkmcnt(3)
    v_mfma_f32_32x32x16_bf16 v[64:79], a[144:147], v[48:51], v[64:79]
    ds_read_b64_tr_b16 v[56:57], v27 offset:49152
    ds_read_b64_tr_b16 v[58:59], v27 offset:49664
    ds_read_b128 a[152:155], v21 offset:32768
    s_waitcnt lgkmcnt(5)
    v_mfma_f32_32x32x16_bf16 v[80:95], a[148:151], v[48:51], v[80:95]
    buffer_load_dwordx4 v13, s[8:11], s54 offen offset:1024 lds
    s_add_u32 m0, s50, 14336
    s_waitcnt lgkmcnt(3)
    v_mfma_f32_32x32x16_bf16 v[96:111], a[144:147], v[52:55], v[96:111]
    ds_read_b128 a[156:159], v21 offset:40960
    ds_read_b64_tr_b16 v[60:61], v27 offset:51200
    ds_read_b64_tr_b16 v[62:63], v27 offset:51712
    v_mfma_f32_32x32x16_bf16 v[112:127], a[148:151], v[52:55], v[112:127]
    buffer_load_dwordx4 v14, s[8:11], s54 offen lds
    v_dot2_f32_bf16 v46, v48, v189, v46
    v_dot2_f32_bf16 v47, v52, v189, v47
    v_dot2_f32_bf16 v46, v49, v189, v46
    v_dot2_f32_bf16 v47, v53, v189, v47
    v_dot2_f32_bf16 v46, v50, v189, v46
    v_dot2_f32_bf16 v47, v54, v189, v47
    v_dot2_f32_bf16 v46, v51, v189, v46
    v_dot2_f32_bf16 v47, v55, v189, v47
    s_waitcnt lgkmcnt(0)
    s_waitcnt vmcnt(12)
    s_barrier
    v_mfma_f32_32x32x16_bf16 v[64:79], a[152:155], v[56:59], v[64:79]
    ds_read_b64_tr_b16 v[48:49], v28 offset:0
    ds_read_b64_tr_b16 v[50:51], v28 offset:512
    ds_read_b128 a[160:163], v22 offset:0
    v_mfma_f32_32x32x16_bf16 v[80:95], a[156:159], v[56:59], v[80:95]
    buffer_load_dwordx4 v15, s[8:11], s54 offen offset:1024 lds
    s_add_u32 m0, s50, 40960
    s_mul_i32 s54, s83, 1536
    s_waitcnt vmcnt(8)
    v_xor_b32 v222, s41, v161
    v_xor_b32 v223, s41, v163
    v_or_b32 v222, v222, v223
    v_mfma_f32_32x32x16_bf16 v[96:111], a[152:155], v[60:63], v[96:111]
    ds_read_b128 a[164:167], v22 offset:8192
    ds_read_b64_tr_b16 v[52:53], v28 offset:2048
    ds_read_b64_tr_b16 v[54:55], v28 offset:2560
    v_mfma_f32_32x32x16_bf16 v[112:127], a[156:159], v[60:63], v[112:127]
    buffer_load_dwordx4 v8, s[4:7], s83 offen lds
    v_xor_b32 v223, s41, v164
    v_or_b32 v222, v222, v223
    v_cmp_ne_u32 vcc, 0, v222
    s_waitcnt lgkmcnt(3)
    v_mfma_f32_32x32x16_bf16 v[64:79], a[160:163], v[48:51], v[64:79]
    ds_read_b64_tr_b16 v[56:57], v29 offset:0
    ds_read_b64_tr_b16 v[58:59], v29 offset:512
    ds_read_b128 a[168:171], v23 offset:0
    s_waitcnt lgkmcnt(5)
    v_mfma_f32_32x32x16_bf16 v[80:95], a[164:167], v[48:51], v[80:95]
    buffer_load_dwordx4 v9, s[4:7], s83 offen offset:1024 lds
    s_cbranch_vccnz L_slow_1
L_back_2:
    v_and_b32 v222, 0xffff, v160
    v_and_b32 v223, 0xffff0000, v160
    s_waitcnt lgkmcnt(3)
    v_mfma_f32_32x32x16_bf16 v[96:111], a[160:163], v[52:55], v[96:111]
    ds_read_b128 a[172:175], v23 offset:8192
    ds_read_b64_tr_b16 v[60:61], v29 offset:2048
    ds_read_b64_tr_b16 v[62:63], v29 offset:2560
    v_mfma_f32_32x32x16_bf16 v[112:127], a[164:167], v[52:55], v[112:127]
    buffer_load_dwordx4 v10, s[4:7], s83 offen offset:2048 lds
    v_xor_b32 v222, 0x8000, v222
    v_rcp_f32 v180, v223
    v_lshl_or_b32 v222, v222, 16, v222
    v_dot2_f32_bf16 v46, v48, v189, v46
    v_dot2_f32_bf16 v47, v52, v189, v47
    v_dot2_f32_bf16 v46, v49, v189, v46
    v_dot2_f32_bf16 v47, v53, v189, v47
    v_dot2_f32_bf16 v46, v50, v189, v46
    v_dot2_f32_bf16 v47, v54, v189, v47
    v_dot2_f32_bf16 v46, v51, v189, v46
    v_dot2_f32_bf16 v47, v55, v189, v47
    s_waitcnt lgkmcnt(3)
    v_mfma_f32_32x32x16_bf16 v[64:79], a[168:171], v[56:59], v[64:79]
    ds_read_b64_tr_b16 v[48:49], v28 offset:16384
    ds_read_b64_tr_b16 v[50:51], v28 offset:16896
    ds_read_b128 a[176:179], v24 offset:0
    s_waitcnt lgkmcnt(5)
    v_mfma_f32_32x32x16_bf16 v[80:95], a[172:175], v[56:59], v[80:95]
    buffer_load_dwordx4 v11, s[4:7], s83 offen offset:3072 lds
    s_add_u32 m0, s50, 45056
    v_lshrrev_b32 v223, 16, v160
    v_and_b32 v168, v4, v222
    v_and_b32 v169, v4, v223
    s_waitcnt lgkmcnt(3)
    v_mfma_f32_32x32x16_bf16 v[96:111], a[168:171], v[60:63], v[96:111]
    ds_read_b128 a[180:183], v24 offset:8192
    ds_read_b64_tr_b16 v[52:53], v28 offset:18432
    ds_read_b64_tr_b16 v[54:55], v28 offset:18944
    v_mfma_f32_32x32x16_bf16 v[112:127], a[172:175], v[60:63], v[112:127]
    buffer_load_dwordx4 v12, s[8:11], s54 offen lds
    v_mul_f32 v181, v187, v180
    v_and_b32 v222, 0xffff, v162
    v_and_b32 v223, 0xffff0000, v162
    s_waitcnt lgkmcnt(3)
    v_mfma_f32_32x32x16_bf16 v[64:79], a[176:179], v[48:51], v[64:79]
    ds_read_b64_tr_b16 v[56:57], v29 offset:16384
    ds_read_b64_tr_b16 v[58:59], v29 offset:16896
    ds_read_b128 a[184:187], v25 offset:0
    s_waitcnt lgkmcnt(5)
    v_mfma_f32_32x32x16_bf16 v[80:95], a[180:183], v[48:51], v[80:95]
    buffer_load_dwordx4 v13, s[8:11], s54 offen offset:1024 lds
    s_add_u32 m0, s50, 47104
    v_xor_b32 v222, 0x8000, v222
    v_rcp_f32 v182, v223
    v_lshl_or_b32 v222, v222, 16, v222
    s_waitcnt lgkmcnt(3)
    v_mfma_f32_32x32x16_bf16 v[96:111], a[176:179], v[52:55], v[96:111]
    ds_read_b128 a[188:191], v25 offset:8192
    ds_read_b64_tr_b16 v[60:61], v29 offset:18432
    ds_read_b64_tr_b16 v[62:63], v29 offset:18944
    v_mfma_f32_32x32x16_bf16 v[112:127], a[180:183], v[52:55], v[112:127]
    buffer_load_dwordx4 v14, s[8:11], s54 offen lds
    v_lshrrev_b32 v223, 16, v162
    v_and_b32 v172, v4, v222
    v_and_b32 v173, v4, v223
    v_dot2_f32_bf16 v46, v48, v189, v46
    v_dot2_f32_bf16 v47, v52, v189, v47
    v_dot2_f32_bf16 v46, v49, v189, v46
    v_dot2_f32_bf16 v47, v53, v189, v47
    v_dot2_f32_bf16 v46, v50, v189, v46
    v_dot2_f32_bf16 v47, v54, v189, v47
    v_dot2_f32_bf16 v46, v51, v189, v46
    v_dot2_f32_bf16 v47, v55, v189, v47
    s_waitcnt lgkmcnt(0)
    s_waitcnt vmcnt(7)
    s_barrier
    v_mfma_f32_32x32x16_bf16 v[64:79], a[184:187], v[56:59], v[64:79]
    ds_read_b64_tr_b16 v[48:49], v26 offset:0
    ds_read_b64_tr_b16 v[50:51], v26 offset:512
    ds_read_b128 a[192:195], v18 offset:0
    v_mfma_f32_32x32x16_bf16 v[80:95], a[188:191], v[56:59], v[80:95]
    buffer_load_dwordx4 v15, s[8:11], s54 offen offset:1024 lds
    s_add_u32 m0, s51, 32768
    s_mul_i32 s54, s79, 1536
    v_mul_f32 v183, v187, v182
    s_lshl_b32 s55, s3, 8
    v_add_u32 v222, s55, v167
    v_mfma_f32_32x32x16_bf16 v[96:111], a[184:187], v[60:63], v[96:111]
    ds_read_b128 a[196:199], v18 offset:8192
    ds_read_b64_tr_b16 v[52:53], v26 offset:2048
    ds_read_b64_tr_b16 v[54:55], v26 offset:2560
    v_mfma_f32_32x32x16_bf16 v[112:127], a[188:191], v[60:63], v[112:127]
    buffer_load_dwordx4 v16, s[8:11], s54 offen lds
    v_lshrrev_b32 v223, 5, v1
    ds_write_b32 v222, v180 offset:0
    ds_write_b32 v222, v182 offset:128
    s_waitcnt lgkmcnt(5)
    v_mfma_f32_32x32x16_bf16 v[64:79], a[192:195], v[48:51], v[64:79]
    ds_read_b64_tr_b16 v[56:57], v27 offset:0
    ds_read_b64_tr_b16 v[58:59], v27 offset:512
    ds_read_b128 a[200:203], v19 offset:0
    s_waitcnt lgkmcnt(7)
    v_mfma_f32_32x32x16_bf16 v[80:95], a[196:199], v[48:51], v[80:95]
    buffer_load_dwordx4 v17, s[8:11], s54 offen offset:1024 lds
    s_add_u32 m0, s51, 40960
    s_mul_i32 s54, s80, 1536
    v_lshl_add_u32 v223, v223, 4, s55
    ds_read_b128 v[190:193], v223 offset:0
    ds_read_b128 v[194:197], v223 offset:32
    s_waitcnt lgkmcnt(7)
    v_mfma_f32_32x32x16_bf16 v[96:111], a[192:195], v[52:55], v[96:111]
    ds_read_b128 a[204:207], v19 offset:8192
    ds_read_b64_tr_b16 v[60:61], v27 offset:2048
    ds_read_b64_tr_b16 v[62:63], v27 offset:2560
    v_mfma_f32_32x32x16_bf16 v[112:127], a[196:199], v[52:55], v[112:127]
    buffer_load_dwordx4 v16, s[8:11], s54 offen lds
    ds_read_b128 v[198:201], v223 offset:64
    ds_read_b128 v[202:205], v223 offset:96
    ds_read_b128 v[206:209], v223 offset:128
    v_dot2_f32_bf16 v46, v48, v189, v46
    v_dot2_f32_bf16 v47, v52, v189, v47
    v_dot2_f32_bf16 v46, v49, v189, v46
    v_dot2_f32_bf16 v47, v53, v189, v47
    v_dot2_f32_bf16 v46, v50, v189, v46
    v_dot2_f32_bf16 v47, v54, v189, v47
    v_dot2_f32_bf16 v46, v51, v189, v46
    v_dot2_f32_bf16 v47, v55, v189, v47
    s_waitcnt lgkmcnt(8)
    v_mfma_f32_32x32x16_bf16 v[64:79], a[200:203], v[56:59], v[64:79]
    ds_read_b64_tr_b16 v[48:49], v26 offset:16384
    ds_read_b64_tr_b16 v[50:51], v26 offset:16896
    ds_read_b128 a[208:211], v20 offset:0
    s_waitcnt lgkmcnt(8)
    v_mfma_f32_32x32x16_bf16 v[80:95], a[204:207], v[56:59], v[80:95]
    buffer_load_dwordx4 v17, s[8:11], s54 offen offset:1024 lds
    s_add_u32 m0, s51, 49152
    s_mul_i32 s54, s81, 1536
    ds_read_b128 v[210:213], v223 offset:160
    ds_read_b128 v[214:217], v223 offset:192
    ds_read_b128 v[218:221], v223 offset:224
    s_waitcnt lgkmcnt(9)
    v_mfma_f32_32x32x16_bf16 v[96:111], a[200:203], v[60:63], v[96:111]
    ds_read_b128 a[212:215], v20 offset:8192
    ds_read_b64_tr_b16 v[52:53], v26 offset:18432
    ds_read_b64_tr_b16 v[54:55], v26 offset:18944
    v_mfma_f32_32x32x16_bf16 v[112:127], a[204:207], v[60:63], v[112:127]
    buffer_load_dwordx4 v16, s[8:11], s54 offen lds
    s_add_u32 s24, s32, 12288
    s_addc_u32 s25, s33, 0
    s_mov_b32 s26, 33542144
    s_waitcnt lgkmcnt(6)
    v_mfma_f32_32x32x16_bf16 v[64:79], a[208:211], v[48:51], v[64:79]
    ds_read_b64_tr_b16 v[56:57], v27 offset:16384
    ds_read_b64_tr_b16 v[58:59], v27 offset:16896
    ds_read_b128 a[216:219], v21 offset:0
    s_waitcnt lgkmcnt(5)
    v_mfma_f32_32x32x16_bf16 v[80:95], a[212:215], v[48:51], v[80:95]
    buffer_load_dwordx4 v17, s[8:11], s54 offen offset:1024 lds
    s_add_u32 m0, s51, 57344
    s_mul_i32 s54, s82, 1536
    v_mov_b32 v161, 0
    v_mov_b32 v162, 0
    v_mov_b32 v163, 0
    s_waitcnt lgkmcnt(3)
    v_mfma_f32_32x32x16_bf16 v[96:111], a[208:211], v[52:55], v[96:111]
    ds_read_b128 a[220:223], v21 offset:8192
    ds_read_b64_tr_b16 v[60:61], v27 offset:18432
    ds_read_b64_tr_b16 v[62:63], v27 offset:18944
    v_mfma_f32_32x32x16_bf16 v[112:127], a[212:215], v[52:55], v[112:127]
    buffer_load_dwordx4 v16, s[8:11], s54 offen lds
    v_and_b32 v222, 19, v1
    v_bfe_u32 v223, v1, 2, 1
    v_lshl_add_u32 v222, v223, 3, v222
    v_dot2_f32_bf16 v46, v48, v189, v46
    v_dot2_f32_bf16 v47, v52, v189, v47
    v_dot2_f32_bf16 v46, v49, v189, v46
    v_dot2_f32_bf16 v47, v53, v189, v47
    v_dot2_f32_bf16 v46, v50, v189, v46
    v_dot2_f32_bf16 v47, v54, v189, v47
    v_dot2_f32_bf16 v46, v51, v189, v46
    v_dot2_f32_bf16 v47, v55, v189, v47
    s_waitcnt lgkmcnt(0)
    s_waitcnt vmcnt(7)
    s_barrier
    v_mfma_f32_32x32x16_bf16 v[64:79], a[216:219], v[56:59], v[64:79]
    ds_read_b64_tr_b16 v[48:49], v26 offset:32768
    ds_read_b64_tr_b16 v[50:51], v26 offset:33280
    ds_read_b128 a[224:227], v18 offset:32768
    v_mfma_f32_32x32x16_bf16 v[80:95], a[220:223], v[56:59], v[80:95]
    buffer_load_dwordx4 v17, s[8:11], s54 offen offset:1024 lds
    s_add_u32 m0, s51, 0
    s_mul_i32 s54, s83, 1536
    v_bfe_u32 v223, v1, 3, 1
    v_lshl_add_u32 v222, v223, 2, v222
    v_lshlrev_b32 v222, 2, v222
    v_lshrrev_b32 v223, 4, v1
    v_cmp_ne_u32 vcc, s39, v223
    v_mfma_f32_32x32x16_bf16 v[96:111], a[216:219], v[60:63], v[96:111]
    ds_read_b128 a[228:231], v18 offset:40960
    ds_read_b64_tr_b16 v[52:53], v26 offset:34816
    ds_read_b64_tr_b16 v[54:55], v26 offset:35328
    v_mfma_f32_32x32x16_bf16 v[112:127], a[220:223], v[60:63], v[112:127]
    buffer_load_dwordx4 v16, s[8:11], s54 offen lds
    v_mov_b32 v223, 2147418112
    v_cndmask_b32 v164, v222, v223, vcc
    s_cmp_eq_u32 s39, 1
    s_cselect_b64 s[48:49], -1, 0
    s_lshl_b32 s55, s3, 10
    s_waitcnt lgkmcnt(3)
    v_mfma_f32_32x32x16_bf16 v[64:79], a[224:227], v[48:51], v[64:79]
    ds_read_b64_tr_b16 v[56:57], v27 offset:32768
    ds_read_b64_tr_b16 v[58:59], v27 offset:33280
    ds_read_b128 a[232:235], v19 offset:32768
    s_waitcnt lgkmcnt(5)
    v_mfma_f32_32x32x16_bf16 v[80:95], a[228:231], v[48:51], v[80:95]
    buffer_load_dwordx4 v17, s[8:11], s54 offen offset:1024 lds
    s_add_u32 m0, s52, 73728
    s_mov_b32 s54, 0
    v_add_u32 v165, s55, v2
    s_lshl_b32 s55, s3, 8
    v_add_u32 v166, s55, v3
    v_xor_b32 v178, 256, v166
    s_lshl_b32 s56, s39, 10
    s_waitcnt lgkmcnt(3)
    v_mfma_f32_32x32x16_bf16 v[96:111], a[224:227], v[52:55], v[96:111]
    ds_read_b128 a[236:239], v19 offset:40960
    ds_read_b64_tr_b16 v[60:61], v27 offset:34816
    ds_read_b64_tr_b16 v[62:63], v27 offset:35328
    v_mfma_f32_32x32x16_bf16 v[112:127], a[228:231], v[52:55], v[112:127]
    buffer_load_dwordx4 v6, s[20:23], s54 offen lds
    s_add_u32 m0, s52, 77824
    s_mov_b32 s54, 32768
    s_add_u32 s63, s56, s71
    v_bfe_u32 v224, v1, 2, 2
    v_lshrrev_b32 v226, 5, v1
    v_lshl_add_u32 v225, v226, 2, v224
    v_lshlrev_b32 v225, 7, v225
    v_dot2_f32_bf16 v46, v48, v189, v46
    v_dot2_f32_bf16 v47, v52, v189, v47
    v_dot2_f32_bf16 v46, v49, v189, v46
    v_dot2_f32_bf16 v47, v53, v189, v47
    v_dot2_f32_bf16 v46, v50, v189, v46
    v_dot2_f32_bf16 v47, v54, v189, v47
    v_dot2_f32_bf16 v46, v51, v189, v46
    v_dot2_f32_bf16 v47, v55, v189, v47
    s_waitcnt lgkmcnt(3)
    v_mfma_f32_32x32x16_bf16 v[64:79], a[232:235], v[56:59], v[64:79]
    ds_read_b64_tr_b16 v[48:49], v26 offset:49152
    ds_read_b64_tr_b16 v[50:51], v26 offset:49664
    ds_read_b128 a[240:243], v20 offset:32768
    s_waitcnt lgkmcnt(5)
    v_mfma_f32_32x32x16_bf16 v[80:95], a[236:239], v[56:59], v[80:95]
    buffer_load_dwordx4 v6, s[20:23], s54 offen lds
    s_add_u32 m0, s52, 81920
    s_mov_b32 s54, 65536
    v_bfe_u32 v226, v1, 4, 1
    v_lshl_add_u32 v225, v226, 5, v225
    v_and_b32 v226, 3, v1
    v_lshl_add_u32 v225, v226, 3, v225
    s_lshl_b32 s55, s40, 11
    s_waitcnt lgkmcnt(3)
    v_mfma_f32_32x32x16_bf16 v[96:111], a[232:235], v[60:63], v[96:111]
    ds_read_b128 a[244:247], v20 offset:40960
    ds_read_b64_tr_b16 v[52:53], v26 offset:51200
    ds_read_b64_tr_b16 v[54:55], v26 offset:51712
    v_mfma_f32_32x32x16_bf16 v[112:127], a[236:239], v[60:63], v[112:127]
    buffer_load_dwordx4 v6, s[20:23], s54 offen lds
    s_add_u32 m0, s52, 86016
    s_mov_b32 s54, 98304
    s_add_u32 s55, s55, 8192
    v_lshrrev_b32 v224, 1, v224
    v_xor_b32 v224, s40, v224
    v_lshl_add_u32 v225, v224, 6, v225
    v_add_u32 v8, s55, v225
    s_waitcnt lgkmcnt(0)
    v_dot2_f32_bf16 v46, v48, v189, v46
    v_dot2_f32_bf16 v47, v52, v189, v47
    v_dot2_f32_bf16 v46, v49, v189, v46
    v_dot2_f32_bf16 v47, v53, v189, v47
    v_dot2_f32_bf16 v46, v50, v189, v46
    v_dot2_f32_bf16 v47, v54, v189, v47
    v_dot2_f32_bf16 v46, v51, v189, v46
    v_dot2_f32_bf16 v47, v55, v189, v47
    v_mfma_f32_32x32x16_bf16 v[64:79], a[240:243], v[48:51], v[64:79]
    ds_read_b64_tr_b16 v[56:57], v27 offset:49152
    ds_read_b64_tr_b16 v[58:59], v27 offset:49664
    ds_read_b128 a[248:251], v21 offset:32768
    v_xor_b32 v9, 64, v8
    v_add_u32 v10, 65536, v8
    v_mfma_f32_32x32x16_bf16 v[80:95], a[244:247], v[48:51], v[80:95]
    ds_read_b128 a[252:255], v21 offset:40960
    ds_read_b64_tr_b16 v[60:61], v27 offset:51200
    ds_read_b64_tr_b16 v[62:63], v27 offset:51712
    s_nop 0
    v_mov_b32 v37, v46
    v_mov_b32 v41, v47
    s_nop 0
    v_permlane32_swap_b32 v37, v46
    v_permlane32_swap_b32 v41, v47
    v_add_f32 v36, v37, v46
    v_add_f32 v40, v41, v47
    v_mfma_f32_32x32x16_bf16 v[96:111], a[240:243], v[52:55], v[96:111]
    ds_write_b32 v254, v36 offset:1024
    ds_write_b32 v254, v40 offset:1280
    v_add_u32 v11, 65536, v9
    v_add_u32 v12, 131072, v8
    v_add_u32 v13, 131072, v9
    v_mfma_f32_32x32x16_bf16 v[112:127], a[244:247], v[52:55], v[112:127]
    s_waitcnt lgkmcnt(0)
    s_barrier
    v_mfma_f32_32x32x16_bf16 v[64:79], a[248:251], v[56:59], v[64:79]
    ds_read_b32 v37, v255 offset:1024
    ds_read_b32 v41, v255 offset:1280
    buffer_load_dwordx4 v6, s[20:23], s54 offen lds
    s_add_u32 m0, s52, 90112
    s_mov_b32 s54, 196608
    v_mfma_f32_32x32x16_bf16 v[80:95], a[252:255], v[56:59], v[80:95]
    s_waitcnt lgkmcnt(0)
    v_add_f32 v36, v36, v37
    v_cvt_pk_bf16_f32 v37, v36, v36
    v_and_b32 v37, 0xffff0000, v37
    v_sub_f32 v38, v36, v37
    v_cvt_pk_bf16_f32 v246, v37, v38
    v_mfma_f32_32x32x16_bf16 v[96:111], a[248:251], v[60:63], v[96:111]
    v_add_f32 v40, v40, v41
    v_cvt_pk_bf16_f32 v41, v40, v40
    v_and_b32 v41, 0xffff0000, v41
    v_sub_f32 v42, v40, v41
    v_cvt_pk_bf16_f32 v250, v41, v42
    v_mfma_f32_32x32x16_bf16 v[112:127], a[252:255], v[60:63], v[112:127]
    buffer_load_dwordx4 v6, s[20:23], s54 offen lds
    s_add_u32 m0, s52, 94208
    s_mov_b32 s54, 229376
    v_mfma_f32_32x32x16_bf16 v[64:79], v[168:171], v[246:249], v[64:79]
    v_mfma_f32_32x32x16_bf16 v[80:95], v[172:175], v[246:249], v[80:95]
    v_mfma_f32_32x32x16_bf16 v[96:111], v[168:171], v[250:253], v[96:111]
    v_mfma_f32_32x32x16_bf16 v[112:127], v[172:175], v[250:253], v[112:127]
    s_nop 8
    v_pk_fma_f32 v[222:223], v[64:65], v[190:191], v[186:187] op_sel:[0,0,0] op_sel_hi:[1,1,0]
    buffer_load_dwordx4 v6, s[20:23], s54 offen lds
    s_add_u32 m0, s52, 8192
    s_mov_b32 s54, 262144
    v_pk_fma_f32 v[224:225], v[66:67], v[192:193], v[186:187] op_sel:[0,0,0] op_sel_hi:[1,1,0]
    v_pk_fma_f32 v[226:227], v[68:69], v[194:195], v[186:187] op_sel:[0,0,0] op_sel_hi:[1,1,0]
    v_pk_fma_f32 v[228:229], v[70:71], v[196:197], v[186:187] op_sel:[0,0,0] op_sel_hi:[1,1,0]
    v_pk_fma_f32 v[230:231], v[222:223], v[186:187], v[188:189] op_sel:[0,1,0] op_sel_hi:[1,1,0]
    v_pk_fma_f32 v[232:233], v[224:225], v[186:187], v[188:189] op_sel:[0,1,0] op_sel_hi:[1,1,0]
    v_pk_fma_f32 v[234:235], v[226:227], v[186:187], v[188:189] op_sel:[0,1,0] op_sel_hi:[1,1,0]
    v_pk_fma_f32 v[236:237], v[228:229], v[186:187], v[188:189] op_sel:[0,1,0] op_sel_hi:[1,1,0]
    v_exp_f32_e64 v230, v230 clamp
    v_exp_f32_e64 v231, v231 clamp
    v_exp_f32_e64 v232, v232 clamp
    v_exp_f32_e64 v233, v233 clamp
    v_exp_f32_e64 v234, v234 clamp
    v_exp_f32_e64 v235, v235 clamp
    buffer_load_dwordx4 v6, s[20:23], s54 offen lds
    s_add_u32 m0, s52, 12288
    s_mov_b32 s54, 294912
    v_exp_f32_e64 v236, v236 clamp
    v_exp_f32_e64 v237, v237 clamp
    v_max_f32 v222, v222, v186
    v_max_f32 v223, v223, v186
    v_max_f32 v224, v224, v186
    v_max_f32 v225, v225, v186
    v_max_f32 v226, v226, v186
    v_max_f32 v227, v227, v186
    v_max_f32 v228, v228, v186
    v_max_f32 v229, v229, v186
    v_pk_add_f32 v[222:223], v[222:223], v[230:231]
    v_pk_add_f32 v[224:225], v[224:225], v[232:233]
    v_pk_add_f32 v[226:227], v[226:227], v[234:235]
    v_pk_add_f32 v[228:229], v[228:229], v[236:237]
    v_cvt_pk_bf16_f32 v128, v222, v223
    v_cvt_pk_bf16_f32 v129, v224, v225
    buffer_load_dwordx4 v6, s[20:23], s54 offen lds
    s_add_u32 m0, s52, 16384
    s_mov_b32 s54, 393216
    v_cvt_pk_bf16_f32 v130, v226, v227
    v_cvt_pk_bf16_f32 v131, v228, v229
    v_pk_fma_f32 v[222:223], v[72:73], v[198:199], v[186:187] op_sel:[0,0,0] op_sel_hi:[1,1,0]
    v_pk_fma_f32 v[224:225], v[74:75], v[200:201], v[186:187] op_sel:[0,0,0] op_sel_hi:[1,1,0]
    v_pk_fma_f32 v[226:227], v[76:77], v[202:203], v[186:187] op_sel:[0,0,0] op_sel_hi:[1,1,0]
    v_pk_fma_f32 v[228:229], v[78:79], v[204:205], v[186:187] op_sel:[0,0,0] op_sel_hi:[1,1,0]
    v_pk_fma_f32 v[230:231], v[222:223], v[186:187], v[188:189] op_sel:[0,1,0] op_sel_hi:[1,1,0]
    v_pk_fma_f32 v[232:233], v[224:225], v[186:187], v[188:189] op_sel:[0,1,0] op_sel_hi:[1,1,0]
    v_pk_fma_f32 v[234:235], v[226:227], v[186:187], v[188:189] op_sel:[0,1,0] op_sel_hi:[1,1,0]
    v_pk_fma_f32 v[236:237], v[228:229], v[186:187], v[188:189] op_sel:[0,1,0] op_sel_hi:[1,1,0]
    v_exp_f32_e64 v230, v230 clamp
    v_exp_f32_e64 v231, v231 clamp
    v_exp_f32_e64 v232, v232 clamp
    v_exp_f32_e64 v233, v233 clamp
    buffer_load_dwordx4 v6, s[20:23], s54 offen lds
    s_add_u32 m0, s52, 20480
    s_mov_b32 s54, 425984
    v_exp_f32_e64 v234, v234 clamp
    v_exp_f32_e64 v235, v235 clamp
    v_exp_f32_e64 v236, v236 clamp
    v_exp_f32_e64 v237, v237 clamp
    v_max_f32 v222, v222, v186
    v_max_f32 v223, v223, v186
    v_max_f32 v224, v224, v186
    v_max_f32 v225, v225, v186
    v_max_f32 v226, v226, v186
    v_max_f32 v227, v227, v186
    v_max_f32 v228, v228, v186
    v_max_f32 v229, v229, v186
    v_pk_add_f32 v[222:223], v[222:223], v[230:231]
    v_pk_add_f32 v[224:225], v[224:225], v[232:233]
    buffer_load_dwordx4 v6, s[20:23], s54 offen lds
    s_add_u32 m0, s52, 24576
    s_mov_b32 s54, 458752
    v_pk_add_f32 v[226:227], v[226:227], v[234:235]
    v_pk_add_f32 v[228:229], v[228:229], v[236:237]
    v_cvt_pk_bf16_f32 v132, v222, v223
    v_cvt_pk_bf16_f32 v133, v224, v225
    v_cvt_pk_bf16_f32 v134, v226, v227
    v_cvt_pk_bf16_f32 v135, v228, v229
    v_pk_fma_f32 v[222:223], v[80:81], v[206:207], v[186:187] op_sel:[0,0,0] op_sel_hi:[1,1,0]
    v_pk_fma_f32 v[224:225], v[82:83], v[208:209], v[186:187] op_sel:[0,0,0] op_sel_hi:[1,1,0]
    v_pk_fma_f32 v[226:227], v[84:85], v[210:211], v[186:187] op_sel:[0,0,0] op_sel_hi:[1,1,0]
    v_pk_fma_f32 v[228:229], v[86:87], v[212:213], v[186:187] op_sel:[0,0,0] op_sel_hi:[1,1,0]
    v_pk_fma_f32 v[230:231], v[222:223], v[186:187], v[188:189] op_sel:[0,1,0] op_sel_hi:[1,1,0]
    v_pk_fma_f32 v[232:233], v[224:225], v[186:187], v[188:189] op_sel:[0,1,0] op_sel_hi:[1,1,0]
    v_pk_fma_f32 v[234:235], v[226:227], v[186:187], v[188:189] op_sel:[0,1,0] op_sel_hi:[1,1,0]
    v_pk_fma_f32 v[236:237], v[228:229], v[186:187], v[188:189] op_sel:[0,1,0] op_sel_hi:[1,1,0]
    v_exp_f32_e64 v230, v230 clamp
    v_exp_f32_e64 v231, v231 clamp
    buffer_load_dwordx4 v6, s[20:23], s54 offen lds
    s_add_u32 m0, s52, 28672
    s_mov_b32 s54, 491520
    v_exp_f32_e64 v232, v232 clamp
    v_exp_f32_e64 v233, v233 clamp
    v_exp_f32_e64 v234, v234 clamp
    v_exp_f32_e64 v235, v235 clamp
    v_exp_f32_e64 v236, v236 clamp
    v_exp_f32_e64 v237, v237 clamp
    v_max_f32 v222, v222, v186
    v_max_f32 v223, v223, v186
    v_max_f32 v224, v224, v186
    v_max_f32 v225, v225, v186
    v_max_f32 v226, v226, v186
    v_max_f32 v227, v227, v186
    buffer_load_dwordx4 v6, s[20:23], s54 offen lds
    s_add_u32 m0, s52, 32768
    s_mov_b32 s54, 589824
    v_max_f32 v228, v228, v186
    v_max_f32 v229, v229, v186
    v_pk_add_f32 v[222:223], v[222:223], v[230:231]
    v_pk_add_f32 v[224:225], v[224:225], v[232:233]
    v_pk_add_f32 v[226:227], v[226:227], v[234:235]
    v_pk_add_f32 v[228:229], v[228:229], v[236:237]
    v_cvt_pk_bf16_f32 v136, v222, v223
    v_cvt_pk_bf16_f32 v137, v224, v225
    v_cvt_pk_bf16_f32 v138, v226, v227
    v_cvt_pk_bf16_f32 v139, v228, v229
    v_pk_fma_f32 v[222:223], v[88:89], v[214:215], v[186:187] op_sel:[0,0,0] op_sel_hi:[1,1,0]
    v_pk_fma_f32 v[224:225], v[90:91], v[216:217], v[186:187] op_sel:[0,0,0] op_sel_hi:[1,1,0]
    v_pk_fma_f32 v[226:227], v[92:93], v[218:219], v[186:187] op_sel:[0,0,0] op_sel_hi:[1,1,0]
    v_pk_fma_f32 v[228:229], v[94:95], v[220:221], v[186:187] op_sel:[0,0,0] op_sel_hi:[1,1,0]
    v_pk_fma_f32 v[230:231], v[222:223], v[186:187], v[188:189] op_sel:[0,1,0] op_sel_hi:[1,1,0]
    v_pk_fma_f32 v[232:233], v[224:225], v[186:187], v[188:189] op_sel:[0,1,0] op_sel_hi:[1,1,0]
    v_pk_fma_f32 v[234:235], v[226:227], v[186:187], v[188:189] op_sel:[0,1,0] op_sel_hi:[1,1,0]
    v_pk_fma_f32 v[236:237], v[228:229], v[186:187], v[188:189] op_sel:[0,1,0] op_sel_hi:[1,1,0]
    buffer_load_dwordx4 v6, s[20:23], s54 offen lds
    s_add_u32 m0, s52, 36864
    s_mov_b32 s54, 622592
    v_exp_f32_e64 v230, v230 clamp
    v_exp_f32_e64 v231, v231 clamp
    v_exp_f32_e64 v232, v232 clamp
    v_exp_f32_e64 v233, v233 clamp
    v_exp_f32_e64 v234, v234 clamp
    v_exp_f32_e64 v235, v235 clamp
    v_exp_f32_e64 v236, v236 clamp
    v_exp_f32_e64 v237, v237 clamp
    v_max_f32 v222, v222, v186
    v_max_f32 v223, v223, v186
    buffer_load_dwordx4 v6, s[20:23], s54 offen lds
    v_max_f32 v224, v224, v186
    v_max_f32 v225, v225, v186
    v_max_f32 v226, v226, v186
    v_max_f32 v227, v227, v186
    v_max_f32 v228, v228, v186
    v_max_f32 v229, v229, v186
    v_pk_add_f32 v[222:223], v[222:223], v[230:231]
    v_pk_add_f32 v[224:225], v[224:225], v[232:233]
    v_pk_add_f32 v[226:227], v[226:227], v[234:235]
    v_pk_add_f32 v[228:229], v[228:229], v[236:237]
    v_cvt_pk_bf16_f32 v140, v222, v223
    v_cvt_pk_bf16_f32 v141, v224, v225
    v_cvt_pk_bf16_f32 v142, v226, v227
    v_cvt_pk_bf16_f32 v143, v228, v229
    v_pk_mul_f32 v[96:97], v[96:97], v[190:191]
    v_pk_mul_f32 v[98:99], v[98:99], v[192:193]
    v_pk_mul_f32 v[100:101], v[100:101], v[194:195]
    v_pk_mul_f32 v[102:103], v[102:103], v[196:197]
    v_pk_mul_f32 v[104:105], v[104:105], v[198:199]
    v_pk_mul_f32 v[106:107], v[106:107], v[200:201]
    buffer_load_dword v176, v177, s[92:95], 0 offen
    s_add_u32 m0, s52, 40960
    s_mov_b32 s54, 655360
    v_pk_mul_f32 v[108:109], v[108:109], v[202:203]
    buffer_load_dwordx4 v6, s[20:23], s54 offen lds
    s_add_u32 m0, s52, 45056
    s_mov_b32 s54, 688128
    v_pk_mul_f32 v[110:111], v[110:111], v[204:205]
    v_cvt_pk_bf16_f32 v144, v96, v97
    v_cvt_pk_bf16_f32 v145, v98, v99
    v_cvt_pk_bf16_f32 v146, v100, v101
    v_cvt_pk_bf16_f32 v147, v102, v103
    v_cvt_pk_bf16_f32 v148, v104, v105
    v_cvt_pk_bf16_f32 v149, v106, v107
    v_cvt_pk_bf16_f32 v150, v108, v109
    v_cvt_pk_bf16_f32 v151, v110, v111
    v_pk_mul_f32 v[112:113], v[112:113], v[206:207]
    v_pk_mul_f32 v[114:115], v[114:115], v[208:209]
    v_pk_mul_f32 v[116:117], v[116:117], v[210:211]
    v_pk_mul_f32 v[118:119], v[118:119], v[212:213]
    v_pk_mul_f32 v[120:121], v[120:121], v[214:215]
    v_pk_mul_f32 v[122:123], v[122:123], v[216:217]
    v_pk_mul_f32 v[124:125], v[124:125], v[218:219]
    v_pk_mul_f32 v[126:127], v[126:127], v[220:221]
    v_cvt_pk_bf16_f32 v152, v112, v113
    buffer_load_dwordx4 v6, s[20:23], s54 offen lds
    s_add_u32 m0, s52, 49152
    s_mov_b32 s54, 786432
    v_cvt_pk_bf16_f32 v153, v114, v115
    v_cvt_pk_bf16_f32 v154, v116, v117
    v_cvt_pk_bf16_f32 v155, v118, v119
    v_cvt_pk_bf16_f32 v156, v120, v121
    v_cvt_pk_bf16_f32 v157, v122, v123
    v_cvt_pk_bf16_f32 v158, v124, v125
    v_cvt_pk_bf16_f32 v159, v126, v127
    v_mfma_f32_32x32x16_bf16 v[64:79], v[128:131], v[144:147], 0
    v_mfma_f32_32x32x16_bf16 v[64:79], v[132:135], v[148:151], v[64:79]
    v_mfma_f32_32x32x16_bf16 v[64:79], v[136:139], v[152:155], v[64:79]
    buffer_load_dwordx4 v6, s[20:23], s54 offen lds
    s_add_u32 m0, s52, 53248
    s_mov_b32 s54, 819200
    v_mfma_f32_32x32x16_bf16 v[64:79], v[140:143], v[156:159], v[64:79]
    v_dot2_f32_bf16 v108, v128, v189, 0
    v_dot2_f32_bf16 v109, v129, v189, 0
    v_dot2_f32_bf16 v108, v130, v189, v108
    v_dot2_f32_bf16 v109, v131, v189, v109
    v_dot2_f32_bf16 v108, v132, v189, v108
    v_dot2_f32_bf16 v109, v133, v189, v109
    v_dot2_f32_bf16 v108, v134, v189, v108
    v_dot2_f32_bf16 v109, v135, v189, v109
    v_dot2_f32_bf16 v108, v136, v189, v108
    v_dot2_f32_bf16 v109, v137, v189, v109
    v_dot2_f32_bf16 v108, v138, v189, v108
    v_dot2_f32_bf16 v109, v139, v189, v109
    v_dot2_f32_bf16 v108, v140, v189, v108
    buffer_load_dwordx4 v6, s[20:23], s54 offen lds
    s_add_u32 m0, s52, 57344
    s_mov_b32 s54, 851968
    v_dot2_f32_bf16 v109, v141, v189, v109
    v_dot2_f32_bf16 v108, v142, v189, v108
    v_dot2_f32_bf16 v109, v143, v189, v109
    s_nop 2
    v_add_f32 v108, v108, v109
    v_mov_b32 v109, v108
    s_nop 1
    v_permlane32_swap_b32 v109, v108
    v_add_f32 v108, v108, v109
    ds_write_b32 v166, v108 offset:3072
    v_cndmask_b32 v100, v72, v64, s[46:47]
    v_cndmask_b32 v101, v73, v65, s[46:47]
    v_cndmask_b32 v102, v74, v66, s[46:47]
    v_cndmask_b32 v103, v75, v67, s[46:47]
    v_cndmask_b32 v104, v76, v68, s[46:47]
    v_cndmask_b32 v105, v77, v69, s[46:47]
    v_cndmask_b32 v106, v78, v70, s[46:47]
    v_cndmask_b32 v107, v79, v71, s[46:47]
    v_cndmask_b32 v116, v104, v100, s[48:49]
    buffer_load_dwordx4 v6, s[20:23], s54 offen lds
    s_add_u32 m0, s52, 61440
    s_mov_b32 s54, 884736
    v_cndmask_b32 v117, v105, v101, s[48:49]
    v_cndmask_b32 v118, v106, v102, s[48:49]
    v_cndmask_b32 v119, v107, v103, s[48:49]
    ds_write_b128 v165, v[116:119] offset:4096
    v_cndmask_b32 v120, v100, v104, s[48:49]
    v_cndmask_b32 v121, v101, v105, s[48:49]
    v_cndmask_b32 v122, v102, v106, s[48:49]
    v_cndmask_b32 v123, v103, v107, s[48:49]
    v_xor_b32 v165, 1024, v165
    s_waitcnt lgkmcnt(0)
    s_barrier
    ds_read_b128 v[124:127], v165 offset:4096
    ds_read_b32 v109, v178 offset:3072
    buffer_load_dwordx4 v6, s[20:23], s54 offen lds
    s_add_u32 m0, s52, 65536
    s_mov_b32 s54, 983040
    s_waitcnt lgkmcnt(0)
    v_add_f32 v120, v120, v124
    buffer_atomic_add_f32 v120, v3, s[32:35], s63 offen offset:0
    v_add_f32 v121, v121, v125
    buffer_atomic_add_f32 v121, v3, s[32:35], s63 offen offset:256
    v_add_f32 v122, v122, v126
    buffer_atomic_add_f32 v122, v3, s[32:35], s63 offen offset:512
    v_add_f32 v123, v123, v127
    buffer_atomic_add_f32 v123, v3, s[32:35], s63 offen offset:768
    v_add_f32 v108, v108, v109
    buffer_atomic_add_f32 v108, v164, s[32:35], s71 offen offset:2048
    s_waitcnt vmcnt(25)
    s_barrier
    ds_read_b64_tr_b16 v[48:49], v30 offset:8192
    ds_read_b64_tr_b16 v[50:51], v30 offset:8704
    ds_read_b64_tr_b16 v[52:53], v31 offset:8192
    ds_read_b64_tr_b16 v[54:55], v31 offset:8704
    s_waitcnt lgkmcnt(2)
    v_mfma_f32_32x32x16_bf16 v[128:143], v[48:51], a[0:3], 0
    ds_read_b64_tr_b16 v[56:57], v30 offset:12288
    ds_read_b64_tr_b16 v[58:59], v30 offset:12800
    v_bfe_u32 v64, v1, 4, 1
    v_xor_b32 v64, 1, v64
    v_mfma_f32_32x32x16_bf16 v[144:159], v[48:51], a[4:7], 0
    buffer_load_dwordx4 v6, s[20:23], s54 offen lds
    s_add_u32 m0, s52, 69632
    s_mov_b32 s54, 1015808
    v_lshrrev_b32 v66, 5, v1
    v_lshlrev_b32 v64, 6, v64
    v_lshl_add_u32 v64, v66, 5, v64
    v_mfma_f32_16x16x32_bf16 v[44:47], v[32:35], v[48:51], 0
    buffer_load_dwordx4 v6, s[20:23], s54 offen lds
    s_waitcnt lgkmcnt(2)
    v_mfma_f32_32x32x16_bf16 v[128:143], v[52:55], a[8:11], v[128:143]
    ds_read_b64_tr_b16 v[60:61], v31 offset:12288
    ds_read_b64_tr_b16 v[62:63], v31 offset:12800
    ds_read_b64_tr_b16 a[0:1], v10 offset:0
    v_mfma_f32_32x32x16_bf16 v[144:159], v[52:55], a[12:15], v[144:159]
    ds_read_b64_tr_b16 a[2:3], v10 offset:1024
    ds_read_b64_tr_b16 a[4:5], v11 offset:0
    ds_read_b64_tr_b16 a[6:7], v11 offset:1024
    s_waitcnt lgkmcnt(4)
    s_waitcnt vmcnt(23)
    s_barrier
    v_mfma_f32_32x32x16_bf16 v[128:143], v[56:59], a[16:19], v[128:143]
    ds_read_b64_tr_b16 v[48:49], v30 offset:16384
    ds_read_b64_tr_b16 v[50:51], v30 offset:16896
    ds_read_b64_tr_b16 a[8:9], v10 offset:4096
    v_mfma_f32_32x32x16_bf16 v[144:159], v[56:59], a[20:23], v[144:159]
    s_add_u32 m0, s52, 106496
    s_mov_b32 s54, 1048576
    buffer_load_dwordx4 v6, s[20:23], s54 offen lds
    s_add_u32 m0, s52, 110592
    s_mov_b32 s54, 1081344
    ds_read_b64_tr_b16 a[10:11], v10 offset:5120
    ds_read_b64_tr_b16 a[12:13], v11 offset:4096
    ds_read_b64_tr_b16 a[14:15], v11 offset:5120
    v_mfma_f32_16x16x32_bf16 v[44:47], v[32:35], v[56:59], v[44:47]
    v_lshrrev_b32 v20, 5, v1
    v_mfma_f32_32x32x16_bf16 v[128:143], v[60:63], a[24:27], v[128:143]
    ds_read_b64_tr_b16 v[52:53], v31 offset:16384
    ds_read_b64_tr_b16 v[54:55], v31 offset:16896
    ds_read_b64_tr_b16 a[16:17], v10 offset:8192
    v_mfma_f32_32x32x16_bf16 v[144:159], v[60:63], a[28:31], v[144:159]
    buffer_load_dwordx4 v6, s[20:23], s54 offen lds
    ds_read_b64_tr_b16 a[18:19], v10 offset:9216
    ds_read_b64_tr_b16 a[20:21], v11 offset:8192
    ds_read_b64_tr_b16 a[22:23], v11 offset:9216
    s_waitcnt lgkmcnt(10)
    v_mfma_f32_32x32x16_bf16 v[128:143], v[48:51], a[32:35], v[128:143]
    ds_read_b64_tr_b16 v[56:57], v30 offset:20480
    ds_read_b64_tr_b16 v[58:59], v30 offset:20992
    ds_read_b64_tr_b16 a[24:25], v10 offset:12288
    v_mfma_f32_32x32x16_bf16 v[144:159], v[48:51], a[36:39], v[144:159]
    ds_read_b64_tr_b16 a[26:27], v10 offset:13312
    ds_read_b64_tr_b16 a[28:29], v11 offset:12288
    ds_read_b64_tr_b16 a[30:31], v11 offset:13312
    v_mfma_f32_16x16x32_bf16 v[44:47], v[32:35], v[48:51], v[44:47]
    s_waitcnt lgkmcnt(10)
    v_mfma_f32_32x32x16_bf16 v[128:143], v[52:55], a[40:43], v[128:143]
    ds_read_b64_tr_b16 v[60:61], v31 offset:20480
    ds_read_b64_tr_b16 v[62:63], v31 offset:20992
    ds_read_b64_tr_b16 a[32:33], v10 offset:16384
    v_mfma_f32_32x32x16_bf16 v[144:159], v[52:55], a[44:47], v[144:159]
    ds_read_b64_tr_b16 a[34:35], v10 offset:17408
    ds_read_b64_tr_b16 a[36:37], v11 offset:16384
    ds_read_b64_tr_b16 a[38:39], v11 offset:17408
    s_waitcnt lgkmcnt(4)
    s_waitcnt vmcnt(21)
    s_barrier
    v_mfma_f32_32x32x16_bf16 v[128:143], v[56:59], a[48:51], v[128:143]
    ds_read_b64_tr_b16 v[48:49], v30 offset:24576
    ds_read_b64_tr_b16 v[50:51], v30 offset:25088
    ds_read_b64_tr_b16 a[40:41], v10 offset:20480
    v_mfma_f32_32x32x16_bf16 v[144:159], v[56:59], a[52:55], v[144:159]
    s_add_u32 m0, s52, 114688
    s_mov_b32 s54, 1179648
    buffer_load_dwordx4 v6, s[20:23], s54 offen lds
    s_add_u32 m0, s52, 118784
    s_mov_b32 s54, 1212416
    ds_read_b64_tr_b16 a[42:43], v10 offset:21504
    ds_read_b64_tr_b16 a[44:45], v11 offset:20480
    ds_read_b64_tr_b16 a[46:47], v11 offset:21504
    v_mfma_f32_16x16x32_bf16 v[44:47], v[32:35], v[56:59], v[44:47]
    s_lshl_b32 s55, s42, 7
    v_mfma_f32_32x32x16_bf16 v[128:143], v[60:63], a[56:59], v[128:143]
    ds_read_b64_tr_b16 v[52:53], v31 offset:24576
    ds_read_b64_tr_b16 v[54:55], v31 offset:25088
    ds_read_b64_tr_b16 a[48:49], v8 offset:0
    v_mfma_f32_32x32x16_bf16 v[144:159], v[60:63], a[60:63], v[144:159]
    s_waitcnt vmcnt(5)
    buffer_store_dword v7, v5, s[32:35], s64 offen sc1
    ds_read_b64_tr_b16 a[50:51], v8 offset:1024
    ds_read_b64_tr_b16 a[52:53], v9 offset:0
    ds_read_b64_tr_b16 a[54:55], v9 offset:1024
    s_waitcnt lgkmcnt(10)
    v_mfma_f32_32x32x16_bf16 v[128:143], v[48:51], a[64:67], v[128:143]
    ds_read_b64_tr_b16 v[56:57], v30 offset:28672
    ds_read_b64_tr_b16 v[58:59], v30 offset:29184
    ds_read_b64_tr_b16 a[56:57], v8 offset:4096
    v_mfma_f32_32x32x16_bf16 v[144:159], v[48:51], a[68:71], v[144:159]
    buffer_load_dwordx4 v6, s[20:23], s54 offen lds
    s_add_u32 m0, s52, 73728
    s_mov_b32 s54, 1245184
    ds_read_b64_tr_b16 a[58:59], v8 offset:5120
    ds_read_b64_tr_b16 a[60:61], v9 offset:4096
    ds_read_b64_tr_b16 a[62:63], v9 offset:5120
    v_mfma_f32_16x16x32_bf16 v[44:47], v[32:35], v[48:51], v[44:47]
    buffer_load_dwordx4 v6, s[20:23], s54 offen lds
    s_add_u32 m0, s52, 77824
    s_mov_b32 s54, 1277952
    s_waitcnt lgkmcnt(10)
    v_mfma_f32_32x32x16_bf16 v[128:143], v[52:55], a[72:75], v[128:143]
    ds_read_b64_tr_b16 v[60:61], v31 offset:28672
    ds_read_b64_tr_b16 v[62:63], v31 offset:29184
    ds_read_b64_tr_b16 a[64:65], v8 offset:8192
    v_mfma_f32_32x32x16_bf16 v[144:159], v[52:55], a[76:79], v[144:159]
    buffer_load_dwordx4 v6, s[20:23], s54 offen lds
    s_add_u32 m0, s52, 81920
    s_mov_b32 s54, 1376256
    ds_read_b64_tr_b16 a[66:67], v8 offset:9216
    ds_read_b64_tr_b16 a[68:69], v9 offset:8192
    ds_read_b64_tr_b16 a[70:71], v9 offset:9216
    s_waitcnt lgkmcnt(4)
    s_barrier
    v_mfma_f32_32x32x16_bf16 v[128:143], v[56:59], a[80:83], v[128:143]
    ds_read_b64_tr_b16 v[48:49], v30 offset:32768
    ds_read_b64_tr_b16 v[50:51], v30 offset:33280
    ds_read_b64_tr_b16 a[72:73], v8 offset:12288
    v_mfma_f32_32x32x16_bf16 v[144:159], v[56:59], a[84:87], v[144:159]
    buffer_load_dwordx4 v6, s[20:23], s54 offen lds
    s_add_u32 m0, s52, 86016
    s_mov_b32 s54, 0
    ds_read_b64_tr_b16 a[74:75], v8 offset:13312
    ds_read_b64_tr_b16 a[76:77], v9 offset:12288
    ds_read_b64_tr_b16 a[78:79], v9 offset:13312
    v_mfma_f32_16x16x32_bf16 v[44:47], v[32:35], v[56:59], v[44:47]
    s_add_u32 s68, s55, 45056
    v_mfma_f32_32x32x16_bf16 v[128:143], v[60:63], a[88:91], v[128:143]
    ds_read_b64_tr_b16 v[52:53], v31 offset:32768
    ds_read_b64_tr_b16 v[54:55], v31 offset:33280
    ds_read_b64_tr_b16 a[80:81], v8 offset:16384
    v_mfma_f32_32x32x16_bf16 v[144:159], v[60:63], a[92:95], v[144:159]
    buffer_load_dwordx4 v6, s[16:19], s54 offen lds
    s_add_u32 m0, s52, 122880
    s_mov_b32 s54, 32768
    ds_read_b64_tr_b16 a[82:83], v8 offset:17408
    ds_read_b64_tr_b16 a[84:85], v9 offset:16384
    ds_read_b64_tr_b16 a[86:87], v9 offset:17408
    s_waitcnt lgkmcnt(10)
    v_mfma_f32_32x32x16_bf16 v[128:143], v[48:51], a[96:99], v[128:143]
    ds_read_b64_tr_b16 v[56:57], v30 offset:36864
    ds_read_b64_tr_b16 v[58:59], v30 offset:37376
    ds_read_b64_tr_b16 a[88:89], v8 offset:20480
    v_mfma_f32_32x32x16_bf16 v[144:159], v[48:51], a[100:103], v[144:159]
    buffer_load_dwordx4 v6, s[16:19], s54 offen lds
    s_add_u32 m0, s52, 126976
    s_mov_b32 s54, 65536
    ds_read_b64_tr_b16 a[90:91], v8 offset:21504
    ds_read_b64_tr_b16 a[92:93], v9 offset:20480
    ds_read_b64_tr_b16 a[94:95], v9 offset:21504
    v_mfma_f32_16x16x32_bf16 v[44:47], v[32:35], v[48:51], v[44:47]
    buffer_load_dwordx4 v6, s[16:19], s54 offen lds
    s_add_u32 m0, s52, 90112
    s_mov_b32 s54, 98304
    s_waitcnt lgkmcnt(10)
    v_mfma_f32_32x32x16_bf16 v[128:143], v[52:55], a[104:107], v[128:143]
    ds_read_b64_tr_b16 v[60:61], v31 offset:36864
    ds_read_b64_tr_b16 v[62:63], v31 offset:37376
    ds_read_b64_tr_b16 a[96:97], v8 offset:24576
    v_mfma_f32_32x32x16_bf16 v[144:159], v[52:55], a[108:111], v[144:159]
    buffer_load_dwordx4 v6, s[16:19], s54 offen lds
    s_add_u32 m0, s52, 94208
    s_mov_b32 s54, 131072
    ds_read_b64_tr_b16 a[98:99], v8 offset:25600
    ds_read_b64_tr_b16 a[100:101], v9 offset:24576
    ds_read_b64_tr_b16 a[102:103], v9 offset:25600
    s_waitcnt lgkmcnt(4)
    s_barrier
    v_mfma_f32_32x32x16_bf16 v[128:143], v[56:59], a[112:115], v[128:143]
    ds_read_b64_tr_b16 v[48:49], v30 offset:40960
    ds_read_b64_tr_b16 v[50:51], v30 offset:41472
    ds_read_b64_tr_b16 a[104:105], v8 offset:28672
    v_mfma_f32_32x32x16_bf16 v[144:159], v[56:59], a[116:119], v[144:159]
    buffer_load_dwordx4 v6, s[16:19], s54 offen lds
    s_add_u32 m0, s52, 8192
    s_mov_b32 s54, 163840
    ds_read_b64_tr_b16 a[106:107], v8 offset:29696
    ds_read_b64_tr_b16 a[108:109], v9 offset:28672
    ds_read_b64_tr_b16 a[110:111], v9 offset:29696
    v_mfma_f32_16x16x32_bf16 v[44:47], v[32:35], v[56:59], v[44:47]
    s_add_u32 s69, s55, 40960
    v_mfma_f32_32x32x16_bf16 v[128:143], v[60:63], a[120:123], v[128:143]
    ds_read_b64_tr_b16 v[52:53], v31 offset:40960
    ds_read_b64_tr_b16 v[54:55], v31 offset:41472
    ds_read_b64_tr_b16 a[112:113], v8 offset:32768
    v_mfma_f32_32x32x16_bf16 v[144:159], v[60:63], a[124:127], v[144:159]
    buffer_load_dwordx4 v6, s[16:19], s54 offen lds
    s_add_u32 m0, s52, 12288
    s_mov_b32 s54, 196608
    ds_read_b64_tr_b16 a[114:115], v8 offset:33792
    ds_read_b64_tr_b16 a[116:117], v9 offset:32768
    ds_read_b64_tr_b16 a[118:119], v9 offset:33792
    s_waitcnt lgkmcnt(10)
    v_mfma_f32_32x32x16_bf16 v[128:143], v[48:51], a[128:131], v[128:143]
    ds_read_b64_tr_b16 v[56:57], v30 offset:45056
    ds_read_b64_tr_b16 v[58:59], v30 offset:45568
    ds_read_b64_tr_b16 a[120:121], v8 offset:36864
    v_mfma_f32_32x32x16_bf16 v[144:159], v[48:51], a[132:135], v[144:159]
    buffer_load_dwordx4 v6, s[16:19], s54 offen lds
    s_add_u32 m0, s52, 131072
    s_mov_b32 s54, 229376
    ds_read_b64_tr_b16 a[122:123], v8 offset:37888
    ds_read_b64_tr_b16 a[124:125], v9 offset:36864
    ds_read_b64_tr_b16 a[126:127], v9 offset:37888
    v_mfma_f32_16x16x32_bf16 v[44:47], v[32:35], v[48:51], v[44:47]
    buffer_load_dwordx4 v6, s[16:19], s54 offen lds
    s_add_u32 m0, s52, 135168
    s_mov_b32 s54, 262144
    s_waitcnt lgkmcnt(10)
    v_mfma_f32_32x32x16_bf16 v[128:143], v[52:55], a[136:139], v[128:143]
    ds_read_b64_tr_b16 v[60:61], v31 offset:45056
    ds_read_b64_tr_b16 v[62:63], v31 offset:45568
    ds_read_b64_tr_b16 a[128:129], v8 offset:40960
    v_mfma_f32_32x32x16_bf16 v[144:159], v[52:55], a[140:143], v[144:159]
    buffer_load_dwordx4 v6, s[16:19], s54 offen lds
    s_add_u32 m0, s52, 16384
    s_mov_b32 s54, 294912
    ds_read_b64_tr_b16 a[130:131], v8 offset:41984
    ds_read_b64_tr_b16 a[132:133], v9 offset:40960
    ds_read_b64_tr_b16 a[134:135], v9 offset:41984
    s_waitcnt lgkmcnt(4)
    s_waitcnt vmcnt(18)
    s_barrier
    v_mfma_f32_32x32x16_bf16 v[128:143], v[56:59], a[144:147], v[128:143]
    ds_read_b64_tr_b16 v[48:49], v30 offset:49152
    ds_read_b64_tr_b16 v[50:51], v30 offset:49664
    ds_read_b64_tr_b16 a[136:137], v8 offset:45056
    v_mfma_f32_32x32x16_bf16 v[144:159], v[56:59], a[148:151], v[144:159]
    buffer_load_dwordx4 v6, s[16:19], s54 offen lds
    s_add_u32 m0, s52, 20480
    s_mov_b32 s54, 327680
    ds_read_b64_tr_b16 a[138:139], v8 offset:46080
    ds_read_b64_tr_b16 a[140:141], v9 offset:45056
    ds_read_b64_tr_b16 a[142:143], v9 offset:46080
    v_mfma_f32_16x16x32_bf16 v[44:47], v[32:35], v[56:59], v[44:47]
    s_add_u32 s70, s55, 49152
    v_mfma_f32_32x32x16_bf16 v[128:143], v[60:63], a[152:155], v[128:143]
    ds_read_b64_tr_b16 v[52:53], v31 offset:49152
    ds_read_b64_tr_b16 v[54:55], v31 offset:49664
    ds_read_b64_tr_b16 a[144:145], v8 offset:49152
    v_mfma_f32_32x32x16_bf16 v[144:159], v[60:63], a[156:159], v[144:159]
    buffer_load_dwordx4 v6, s[16:19], s54 offen lds
    s_add_u32 m0, s52, 24576
    s_mov_b32 s54, 360448
    ds_read_b64_tr_b16 a[146:147], v8 offset:50176
    ds_read_b64_tr_b16 a[148:149], v9 offset:49152
    ds_read_b64_tr_b16 a[150:151], v9 offset:50176
    s_waitcnt lgkmcnt(10)
    v_mfma_f32_32x32x16_bf16 v[128:143], v[48:51], a[160:163], v[128:143]
    ds_read_b64_tr_b16 v[56:57], v30 offset:53248
    ds_read_b64_tr_b16 v[58:59], v30 offset:53760
    ds_read_b64_tr_b16 a[152:153], v8 offset:53248
    v_mfma_f32_32x32x16_bf16 v[144:159], v[48:51], a[164:167], v[144:159]
    buffer_load_dwordx4 v6, s[16:19], s54 offen lds
    s_add_u32 m0, s52, 28672
    s_mov_b32 s54, 393216
    ds_read_b64_tr_b16 a[154:155], v8 offset:54272
    ds_read_b64_tr_b16 a[156:157], v9 offset:53248
    ds_read_b64_tr_b16 a[158:159], v9 offset:54272
    v_mfma_f32_16x16x32_bf16 v[44:47], v[32:35], v[48:51], v[44:47]
    buffer_load_dwordx4 v6, s[16:19], s54 offen lds
    s_add_u32 m0, s52, 139264
    s_mov_b32 s54, 425984
    s_waitcnt lgkmcnt(10)
    v_mfma_f32_32x32x16_bf16 v[128:143], v[52:55], a[168:171], v[128:143]
    ds_read_b64_tr_b16 v[60:61], v31 offset:53248
    ds_read_b64_tr_b16 v[62:63], v31 offset:53760
    ds_read_b64_tr_b16 a[160:161], v8 offset:57344
    v_mfma_f32_32x32x16_bf16 v[144:159], v[52:55], a[172:175], v[144:159]
    buffer_load_dwordx4 v6, s[16:19], s54 offen lds
    s_add_u32 m0, s52, 143360
    s_mov_b32 s54, 458752
    ds_read_b64_tr_b16 a[162:163], v8 offset:58368
    ds_read_b64_tr_b16 a[164:165], v9 offset:57344
    ds_read_b64_tr_b16 a[166:167], v9 offset:58368
    s_waitcnt lgkmcnt(4)
    s_barrier
    v_mfma_f32_32x32x16_bf16 v[128:143], v[56:59], a[176:179], v[128:143]
    ds_read_b64_tr_b16 v[48:49], v30 offset:57344
    ds_read_b64_tr_b16 v[50:51], v30 offset:57856
    s_lshl_b32 s55, s42, 1
    s_add_u32 s55, s55, s39
    v_mfma_f32_32x32x16_bf16 v[144:159], v[56:59], a[180:183], v[144:159]
    buffer_load_dwordx4 v6, s[16:19], s54 offen lds
    s_add_u32 m0, s52, 32768
    s_mov_b32 s54, 491520
    s_lshl_b32 s56, s55, 7
    s_add_u32 s56, s56, s40
    s_lshl_b32 s56, s56, 10
    v_mfma_f32_16x16x32_bf16 v[44:47], v[32:35], v[56:59], v[44:47]
    s_add_u32 s72, s56, 1048576
    v_mfma_f32_32x32x16_bf16 v[128:143], v[60:63], a[184:187], v[128:143]
    ds_read_b64_tr_b16 v[52:53], v31 offset:57344
    ds_read_b64_tr_b16 v[54:55], v31 offset:57856
    s_lshl1_add_u32 s55, s55, s40
    s_lshl_b32 s55, s55, 14
    v_mfma_f32_32x32x16_bf16 v[144:159], v[60:63], a[188:191], v[144:159]
    buffer_load_dwordx4 v6, s[16:19], s54 offen lds
    s_add_u32 m0, s52, 36864
    s_mov_b32 s54, 131072
    s_lshl_b32 s56, s43, 7
    s_add_u32 s55, s55, s56
    v_lshrrev_b32 v21, 3, v1
    s_waitcnt lgkmcnt(2)
    v_mfma_f32_32x32x16_bf16 v[128:143], v[48:51], a[192:195], v[128:143]
    ds_read_b64_tr_b16 v[56:57], v30 offset:61440
    ds_read_b64_tr_b16 v[58:59], v30 offset:61952
    v_and_b32 v22, 7, v1
    v_lshl_add_u32 v0, v22, 4, s55
    v_mfma_f32_32x32x16_bf16 v[144:159], v[48:51], a[196:199], v[144:159]
    buffer_load_dwordx4 v6, s[20:23], s54 offen lds
    s_add_u32 m0, s52, 40960
    s_mov_b32 s54, 163840
    v_lshl_add_u32 v0, v21, 10, v0
    s_movk_i32 s90, 8192
    s_mov_b32 s30, 2097152
    v_mfma_f32_16x16x32_bf16 v[44:47], v[32:35], v[48:51], v[44:47]
    buffer_load_dwordx4 v6, s[20:23], s54 offen lds
    s_add_u32 m0, s52, 45056
    s_mov_b32 s54, 327680
    s_waitcnt lgkmcnt(2)
    v_mfma_f32_32x32x16_bf16 v[128:143], v[52:55], a[200:203], v[128:143]
    ds_read_b64_tr_b16 v[60:61], v31 offset:61440
    ds_read_b64_tr_b16 v[62:63], v31 offset:61952
    s_mov_b32 s31, 0x20000
    v_and_b32 v14, 60, v167
    v_mfma_f32_32x32x16_bf16 v[144:159], v[52:55], a[204:207], v[144:159]
    buffer_load_dwordx4 v6, s[20:23], s54 offen lds
    s_add_u32 m0, s52, 147456
    s_mov_b32 s54, 360448
    v_bfe_u32 v23, v167, 2, 3
    v_xor_b32 v23, v23, v20
    s_lshl_b32 s55, s3, 13
    s_waitcnt lgkmcnt(0)
    s_barrier
    v_mfma_f32_32x32x16_bf16 v[128:143], v[56:59], a[208:211], v[128:143]
    ds_read_b64_tr_b16 v[48:49], v30 offset:0
    ds_read_b64_tr_b16 v[50:51], v30 offset:512
    s_lshl_b32 s56, s40, 7
    s_add_u32 s55, s55, s56
    v_mfma_f32_32x32x16_bf16 v[144:159], v[56:59], a[212:215], v[144:159]
    buffer_load_dwordx4 v6, s[20:23], s54 offen lds
    s_add_u32 m0, s52, 151552
    s_mov_b32 s54, 524288
    s_add_u32 s55, s55, 106496
    v_lshl_add_u32 v23, v23, 4, s55
    v_lshl_add_u32 v19, v167, 6, v23
    v_mfma_f32_16x16x32_bf16 v[44:47], v[32:35], v[56:59], v[44:47]
    v_lshlrev_b32 v22, 1, v22
    v_mfma_f32_32x32x16_bf16 v[128:143], v[60:63], a[216:219], v[128:143]
    ds_read_b64_tr_b16 v[52:53], v31 offset:0
    ds_read_b64_tr_b16 v[54:55], v31 offset:512
    v_xor_b32 v22, v22, v21
    s_lshl_b32 s55, s39, 13
    v_mfma_f32_32x32x16_bf16 v[144:159], v[60:63], a[220:223], v[144:159]
    buffer_load_dwordx4 v6, s[20:23], s54 offen lds
    s_add_u32 m0, s52, 49152
    s_mov_b32 s54, 557056
    s_lshl_b32 s56, s40, 12
    s_add_u32 s55, s55, s56
    s_add_u32 s55, s55, 106496
    s_waitcnt lgkmcnt(2)
    v_mfma_f32_32x32x16_bf16 v[128:143], v[48:51], a[224:227], v[128:143]
    ds_read_b64_tr_b16 v[56:57], v30 offset:4096
    ds_read_b64_tr_b16 v[58:59], v30 offset:4608
    v_lshl_add_u32 v22, v22, 4, s55
    v_lshl_add_u32 v20, v21, 8, v22
    v_mfma_f32_32x32x16_bf16 v[144:159], v[48:51], a[228:231], v[144:159]
    buffer_load_dwordx4 v6, s[20:23], s54 offen lds
    s_add_u32 m0, s52, 53248
    s_mov_b32 s54, 720896
    v_mfma_f32_16x16x32_bf16 v[44:47], v[32:35], v[48:51], v[44:47]
    buffer_load_dwordx4 v6, s[20:23], s54 offen lds
    s_add_u32 m0, s52, 57344
    s_mov_b32 s54, 753664
    s_waitcnt lgkmcnt(2)
    v_mfma_f32_32x32x16_bf16 v[128:143], v[52:55], a[232:235], v[128:143]
    ds_read_b64_tr_b16 v[60:61], v31 offset:4096
    ds_read_b64_tr_b16 v[62:63], v31 offset:4608
    v_mfma_f32_32x32x16_bf16 v[144:159], v[52:55], a[236:239], v[144:159]
    buffer_load_dwordx4 v6, s[20:23], s54 offen lds
    s_add_u32 m0, s52, 61440
    s_mov_b32 s54, 917504
    s_waitcnt lgkmcnt(2)
    v_mfma_f32_16x16x32_bf16 v[44:47], v[32:35], v[56:59], v[44:47]
    v_mfma_f32_32x32x16_bf16 v[128:143], v[56:59], a[240:243], v[128:143]
    s_nop 6
    ds_write_b32 v254, v44 offset:1024
    v_mfma_f32_32x32x16_bf16 v[144:159], v[56:59], a[244:247], v[144:159]
    buffer_load_dword v65, v167, s[32:35], s67 offen sc1
    s_waitcnt lgkmcnt(0)
    s_barrier
    v_mfma_f32_32x32x16_bf16 v[128:143], v[60:63], a[248:251], v[128:143]
    ds_read_b32 v45, v255 offset:1024
    buffer_load_dwordx4 v6, s[20:23], s54 offen lds
    s_add_u32 m0, s52, 155648
    s_mov_b32 s54, 950272
    v_mfma_f32_32x32x16_bf16 v[144:159], v[60:63], a[252:255], v[144:159]
    s_waitcnt lgkmcnt(0)
    v_add_f32 v44, v44, v45
    v_cvt_pk_bf16_f32 v45, v44, v44
    v_and_b32 v45, 0xffff0000, v45
    v_sub_f32 v46, v44, v45
    v_cvt_pk_bf16_f32 v160, v45, v46
    s_nop 1
    v_mfma_f32_32x32x16_bf16 v[128:143], v[160:163], v[168:171], v[128:143]
    v_mfma_f32_32x32x16_bf16 v[144:159], v[160:163], v[172:175], v[144:159]
    s_lshl_b32 s58, s38, 1
    s_add_u32 s58, s58, s40
    s_lshl_b32 s58, s58, 11
    s_add_u32 s58, s58, s59
    s_add_u32 s58, s58, 98304
    s_nop 5
    v_pk_fma_f32 v[222:223], v[128:129], v[180:181], v[186:187] op_sel:[0,0,0] op_sel_hi:[1,0,0]
    buffer_load_dwordx4 v6, s[20:23], s54 offen lds
    s_add_u32 m0, s52, 159744
    s_mov_b32 s54, 1114112
    v_pk_fma_f32 v[224:225], v[130:131], v[180:181], v[186:187] op_sel:[0,0,0] op_sel_hi:[1,0,0]
    v_pk_fma_f32 v[226:227], v[132:133], v[180:181], v[186:187] op_sel:[0,0,0] op_sel_hi:[1,0,0]
    v_pk_fma_f32 v[228:229], v[134:135], v[180:181], v[186:187] op_sel:[0,0,0] op_sel_hi:[1,0,0]
    v_pk_fma_f32 v[230:231], v[222:223], v[186:187], v[188:189] op_sel:[0,1,0] op_sel_hi:[1,1,0]
    v_pk_fma_f32 v[232:233], v[224:225], v[186:187], v[188:189] op_sel:[0,1,0] op_sel_hi:[1,1,0]
    v_pk_fma_f32 v[234:235], v[226:227], v[186:187], v[188:189] op_sel:[0,1,0] op_sel_hi:[1,1,0]
    v_pk_fma_f32 v[236:237], v[228:229], v[186:187], v[188:189] op_sel:[0,1,0] op_sel_hi:[1,1,0]
    v_exp_f32_e64 v230, v230 clamp
    v_exp_f32_e64 v231, v231 clamp
    v_exp_f32_e64 v232, v232 clamp
    v_exp_f32_e64 v233, v233 clamp
    v_exp_f32_e64 v234, v234 clamp
    v_exp_f32_e64 v235, v235 clamp
    buffer_load_dwordx4 v6, s[20:23], s54 offen lds
    s_add_u32 m0, s52, 65536
    s_mov_b32 s54, 1146880
    v_exp_f32_e64 v236, v236 clamp
    v_exp_f32_e64 v237, v237 clamp
    v_max_f32 v222, v222, v186
    v_max_f32 v223, v223, v186
    v_max_f32 v224, v224, v186
    v_max_f32 v225, v225, v186
    v_max_f32 v226, v226, v186
    v_max_f32 v227, v227, v186
    v_max_f32 v228, v228, v186
    v_max_f32 v229, v229, v186
    v_pk_add_f32 v[222:223], v[222:223], v[230:231]
    v_pk_add_f32 v[224:225], v[224:225], v[232:233]
    v_pk_add_f32 v[226:227], v[226:227], v[234:235]
    v_pk_add_f32 v[228:229], v[228:229], v[236:237]
    v_cvt_pk_bf16_f32 v112, v222, v223
    v_cvt_pk_bf16_f32 v113, v224, v225
    buffer_load_dwordx4 v6, s[20:23], s54 offen lds
    s_add_u32 m0, s52, 98304
    s_mov_b32 s54, 1310720
    v_cvt_pk_bf16_f32 v114, v226, v227
    v_cvt_pk_bf16_f32 v115, v228, v229
    v_pk_fma_f32 v[222:223], v[136:137], v[180:181], v[186:187] op_sel:[0,0,0] op_sel_hi:[1,0,0]
    v_pk_fma_f32 v[224:225], v[138:139], v[180:181], v[186:187] op_sel:[0,0,0] op_sel_hi:[1,0,0]
    v_pk_fma_f32 v[226:227], v[140:141], v[180:181], v[186:187] op_sel:[0,0,0] op_sel_hi:[1,0,0]
    v_pk_fma_f32 v[228:229], v[142:143], v[180:181], v[186:187] op_sel:[0,0,0] op_sel_hi:[1,0,0]
    v_pk_fma_f32 v[230:231], v[222:223], v[186:187], v[188:189] op_sel:[0,1,0] op_sel_hi:[1,1,0]
    v_pk_fma_f32 v[232:233], v[224:225], v[186:187], v[188:189] op_sel:[0,1,0] op_sel_hi:[1,1,0]
    v_pk_fma_f32 v[234:235], v[226:227], v[186:187], v[188:189] op_sel:[0,1,0] op_sel_hi:[1,1,0]
    v_pk_fma_f32 v[236:237], v[228:229], v[186:187], v[188:189] op_sel:[0,1,0] op_sel_hi:[1,1,0]
    v_exp_f32_e64 v230, v230 clamp
    v_exp_f32_e64 v231, v231 clamp
    v_exp_f32_e64 v232, v232 clamp
    v_exp_f32_e64 v233, v233 clamp
    buffer_load_dwordx4 v6, s[20:23], s54 offen lds
    s_add_u32 m0, s52, 102400
    s_mov_b32 s54, 1343488
    v_exp_f32_e64 v234, v234 clamp
    v_exp_f32_e64 v235, v235 clamp
    v_exp_f32_e64 v236, v236 clamp
    v_exp_f32_e64 v237, v237 clamp
    v_max_f32 v222, v222, v186
    v_max_f32 v223, v223, v186
    v_max_f32 v224, v224, v186
    v_max_f32 v225, v225, v186
    v_max_f32 v226, v226, v186
    v_max_f32 v227, v227, v186
    v_max_f32 v228, v228, v186
    v_max_f32 v229, v229, v186
    v_pk_add_f32 v[222:223], v[222:223], v[230:231]
    v_pk_add_f32 v[224:225], v[224:225], v[232:233]
    buffer_load_dwordx4 v6, s[20:23], s54 offen lds
    v_pk_add_f32 v[226:227], v[226:227], v[234:235]
    v_pk_add_f32 v[228:229], v[228:229], v[236:237]
    v_cvt_pk_bf16_f32 v116, v222, v223
    v_cvt_pk_bf16_f32 v117, v224, v225
    v_cvt_pk_bf16_f32 v118, v226, v227
    v_cvt_pk_bf16_f32 v119, v228, v229
    s_waitcnt vmcnt(6)
    v_cmp_ne_u32 vcc, s41, v65
    s_cbranch_vccnz L_slow_3
L_back_4:
    buffer_load_dword v96, v3, s[32:35], s71 offen offset:0 sc1
    buffer_load_dword v97, v3, s[32:35], s71 offen offset:256 sc1
    buffer_load_dword v98, v3, s[32:35], s71 offen offset:512 sc1
    buffer_load_dword v99, v3, s[32:35], s71 offen offset:768 sc1
    buffer_load_dword v100, v3, s[32:35], s71 offen offset:1024 sc1
    buffer_load_dword v101, v3, s[32:35], s71 offen offset:1280 sc1
    buffer_load_dword v102, v3, s[32:35], s71 offen offset:1536 sc1
    buffer_load_dword v103, v3, s[32:35], s71 offen offset:1792 sc1
    buffer_load_dwordx4 v[104:107], v64, s[32:35], s71 offen offset:2048 sc1
    buffer_load_dwordx4 v[108:111], v64, s[32:35], s71 offen offset:2064 sc1
    buffer_load_dword v15, v14, s[32:35], s68 offen sc1
    v_pk_fma_f32 v[222:223], v[144:145], v[182:183], v[186:187] op_sel:[0,0,0] op_sel_hi:[1,0,0]
    v_pk_fma_f32 v[224:225], v[146:147], v[182:183], v[186:187] op_sel:[0,0,0] op_sel_hi:[1,0,0]
    v_pk_fma_f32 v[226:227], v[148:149], v[182:183], v[186:187] op_sel:[0,0,0] op_sel_hi:[1,0,0]
    v_pk_fma_f32 v[228:229], v[150:151], v[182:183], v[186:187] op_sel:[0,0,0] op_sel_hi:[1,0,0]
    v_pk_fma_f32 v[230:231], v[222:223], v[186:187], v[188:189] op_sel:[0,1,0] op_sel_hi:[1,1,0]
    v_pk_fma_f32 v[232:233], v[224:225], v[186:187], v[188:189] op_sel:[0,1,0] op_sel_hi:[1,1,0]
    v_pk_fma_f32 v[234:235], v[226:227], v[186:187], v[188:189] op_sel:[0,1,0] op_sel_hi:[1,1,0]
    v_pk_fma_f32 v[236:237], v[228:229], v[186:187], v[188:189] op_sel:[0,1,0] op_sel_hi:[1,1,0]
    v_exp_f32_e64 v230, v230 clamp
    v_exp_f32_e64 v231, v231 clamp
    v_exp_f32_e64 v232, v232 clamp
    v_exp_f32_e64 v233, v233 clamp
    v_exp_f32_e64 v234, v234 clamp
    v_exp_f32_e64 v235, v235 clamp
    v_exp_f32_e64 v236, v236 clamp
    v_exp_f32_e64 v237, v237 clamp
    v_max_f32 v222, v222, v186
    v_max_f32 v223, v223, v186
    v_max_f32 v224, v224, v186
    v_max_f32 v225, v225, v186
    v_max_f32 v226, v226, v186
    v_max_f32 v227, v227, v186
    v_max_f32 v228, v228, v186
    v_max_f32 v229, v229, v186
    v_pk_add_f32 v[222:223], v[222:223], v[230:231]
    v_pk_add_f32 v[224:225], v[224:225], v[232:233]
    v_pk_add_f32 v[226:227], v[226:227], v[234:235]
    v_pk_add_f32 v[228:229], v[228:229], v[236:237]
    v_cvt_pk_bf16_f32 v120, v222, v223
    v_cvt_pk_bf16_f32 v121, v224, v225
    v_cvt_pk_bf16_f32 v122, v226, v227
    v_cvt_pk_bf16_f32 v123, v228, v229
    v_pk_fma_f32 v[222:223], v[152:153], v[182:183], v[186:187] op_sel:[0,0,0] op_sel_hi:[1,0,0]
    v_pk_fma_f32 v[224:225], v[154:155], v[182:183], v[186:187] op_sel:[0,0,0] op_sel_hi:[1,0,0]
    v_pk_fma_f32 v[226:227], v[156:157], v[182:183], v[186:187] op_sel:[0,0,0] op_sel_hi:[1,0,0]
    v_pk_fma_f32 v[228:229], v[158:159], v[182:183], v[186:187] op_sel:[0,0,0] op_sel_hi:[1,0,0]
    v_pk_fma_f32 v[230:231], v[222:223], v[186:187], v[188:189] op_sel:[0,1,0] op_sel_hi:[1,1,0]
    v_pk_fma_f32 v[232:233], v[224:225], v[186:187], v[188:189] op_sel:[0,1,0] op_sel_hi:[1,1,0]
    v_pk_fma_f32 v[234:235], v[226:227], v[186:187], v[188:189] op_sel:[0,1,0] op_sel_hi:[1,1,0]
    v_pk_fma_f32 v[236:237], v[228:229], v[186:187], v[188:189] op_sel:[0,1,0] op_sel_hi:[1,1,0]
    v_exp_f32_e64 v230, v230 clamp
    v_exp_f32_e64 v231, v231 clamp
    v_exp_f32_e64 v232, v232 clamp
    v_exp_f32_e64 v233, v233 clamp
    v_exp_f32_e64 v234, v234 clamp
    v_exp_f32_e64 v235, v235 clamp
    v_exp_f32_e64 v236, v236 clamp
    v_exp_f32_e64 v237, v237 clamp
    v_max_f32 v222, v222, v186
    v_max_f32 v223, v223, v186
    v_max_f32 v224, v224, v186
    v_max_f32 v225, v225, v186
    v_max_f32 v226, v226, v186
    v_max_f32 v227, v227, v186
    v_max_f32 v228, v228, v186
    v_max_f32 v229, v229, v186
    v_pk_add_f32 v[222:223], v[222:223], v[230:231]
    v_pk_add_f32 v[224:225], v[224:225], v[232:233]
    v_pk_add_f32 v[226:227], v[226:227], v[234:235]
    v_pk_add_f32 v[228:229], v[228:229], v[236:237]
    v_cvt_pk_bf16_f32 v124, v222, v223
    v_cvt_pk_bf16_f32 v125, v224, v225
    v_cvt_pk_bf16_f32 v126, v226, v227
    v_cvt_pk_bf16_f32 v127, v228, v229
    s_waitcnt vmcnt(1)
    v_cvt_pk_bf16_f32 v64, v96, v97
    v_cvt_pk_bf16_f32 v68, v104, v105
    v_cvt_pk_bf16_f32 v65, v98, v99
    v_cvt_pk_bf16_f32 v69, v106, v107
    v_cvt_pk_bf16_f32 v66, v100, v101
    v_cvt_pk_bf16_f32 v70, v108, v109
    v_cvt_pk_bf16_f32 v67, v102, v103
    v_cvt_pk_bf16_f32 v71, v110, v111
    v_cndmask_b32 v72, v68, v64, s[46:47]
    v_cndmask_b32 v76, v64, v68, s[46:47]
    v_cndmask_b32 v73, v69, v65, s[46:47]
    v_cndmask_b32 v77, v65, v69, s[46:47]
    v_cndmask_b32 v74, v70, v66, s[46:47]
    v_cndmask_b32 v78, v66, v70, s[46:47]
    v_cndmask_b32 v75, v71, v67, s[46:47]
    v_cndmask_b32 v79, v67, v71, s[46:47]
    s_nop 0
    v_mfma_f32_32x32x16_bf16 v[190:205], v[72:75], v[112:115], 0
    v_mfma_f32_32x32x16_bf16 v[206:221], v[76:79], v[116:119], 0
    v_mfma_f32_32x32x16_bf16 v[128:143], v[72:75], v[120:123], 0
    v_mfma_f32_32x32x16_bf16 v[144:159], v[76:79], v[124:127], 0
    s_waitcnt vmcnt(0)
    v_cmp_ne_u32 vcc, s41, v15
    s_cbranch_vccnz L_slow_5
L_back_6:
    s_nop 5
    v_add_f32 v198, v186, v198
    buffer_load_dwordx4 v[246:249], v0, s[4:7], 0 offen
    v_rcp_f32 v198, v198
    s_nop 0
    v_pk_mul_f32 v[190:191], v[190:191], v[198:199] op_sel_hi:[1,0]
    v_pk_mul_f32 v[192:193], v[192:193], v[198:199] op_sel_hi:[1,0]
    v_pk_mul_f32 v[194:195], v[194:195], v[198:199] op_sel_hi:[1,0]
    v_pk_mul_f32 v[196:197], v[196:197], v[198:199] op_sel_hi:[1,0]
    v_cvt_pk_bf16_f32 v80, v190, v191
    v_cvt_pk_bf16_f32 v81, v192, v193
    v_cvt_pk_bf16_f32 v82, v194, v195
    v_cvt_pk_bf16_f32 v83, v196, v197
    buffer_store_dwordx4 v[80:83], v2, s[32:35], s58 offen sc1
    v_add_f32 v206, v186, v206
    v_rcp_f32 v206, v206
    s_nop 0
    v_pk_mul_f32 v[214:215], v[214:215], v[206:207] op_sel_hi:[1,0]
    v_pk_mul_f32 v[216:217], v[216:217], v[206:207] op_sel_hi:[1,0]
    v_pk_mul_f32 v[218:219], v[218:219], v[206:207] op_sel_hi:[1,0]
    v_pk_mul_f32 v[220:221], v[220:221], v[206:207] op_sel_hi:[1,0]
    v_cvt_pk_bf16_f32 v84, v214, v215
    v_cvt_pk_bf16_f32 v85, v216, v217
    v_cvt_pk_bf16_f32 v86, v218, v219
    v_cvt_pk_bf16_f32 v87, v220, v221
    buffer_store_dwordx4 v[84:87], v2, s[32:35], s58 offen offset:1024 sc1
    s_add_u32 s58, s58, 131072
    v_add_f32 v136, v186, v136
    v_rcp_f32 v136, v136
    s_nop 0
    v_pk_mul_f32 v[128:129], v[128:129], v[136:137] op_sel_hi:[1,0]
    v_pk_mul_f32 v[130:131], v[130:131], v[136:137] op_sel_hi:[1,0]
    v_pk_mul_f32 v[132:133], v[132:133], v[136:137] op_sel_hi:[1,0]
    v_pk_mul_f32 v[134:135], v[134:135], v[136:137] op_sel_hi:[1,0]
    v_cvt_pk_bf16_f32 v88, v128, v129
    v_cvt_pk_bf16_f32 v89, v130, v131
    v_cvt_pk_bf16_f32 v90, v132, v133
    v_cvt_pk_bf16_f32 v91, v134, v135
    buffer_store_dwordx4 v[88:91], v2, s[32:35], s58 offen sc1
    v_add_f32 v144, v186, v144
    v_rcp_f32 v144, v144
    s_nop 0
    v_pk_mul_f32 v[152:153], v[152:153], v[144:145] op_sel_hi:[1,0]
    v_pk_mul_f32 v[154:155], v[154:155], v[144:145] op_sel_hi:[1,0]
    v_pk_mul_f32 v[156:157], v[156:157], v[144:145] op_sel_hi:[1,0]
    v_pk_mul_f32 v[158:159], v[158:159], v[144:145] op_sel_hi:[1,0]
    v_cvt_pk_bf16_f32 v92, v152, v153
    v_cvt_pk_bf16_f32 v93, v154, v155
    v_cvt_pk_bf16_f32 v94, v156, v157
    v_cvt_pk_bf16_f32 v95, v158, v159
    buffer_store_dwordx4 v[92:95], v2, s[32:35], s58 offen offset:1024 sc1
    buffer_load_dwordx4 v[250:253], v0, s[4:7], s90 offen
    s_add_u32 s73, s72, 0
    buffer_load_dwordx4 a[168:171], v2, s[32:35], s73 offen sc1
    s_add_u32 s73, s72, 2048
    buffer_load_dwordx4 a[172:175], v2, s[32:35], s73 offen sc1
    s_add_u32 s73, s72, 4096
    buffer_load_dwordx4 a[176:179], v2, s[32:35], s73 offen sc1
    s_add_u32 s73, s72, 6144
    buffer_load_dwordx4 a[180:183], v2, s[32:35], s73 offen sc1
    s_add_u32 s73, s72, 12288
    buffer_load_dwordx4 a[184:187], v2, s[32:35], s73 offen sc1
    s_add_u32 s73, s72, 14336
    buffer_load_dwordx4 a[188:191], v2, s[32:35], s73 offen sc1
    s_add_u32 s73, s72, 16384
    buffer_load_dwordx4 a[192:195], v2, s[32:35], s73 offen sc1
    s_add_u32 s73, s72, 18432
    buffer_load_dwordx4 a[196:199], v2, s[32:35], s73 offen sc1
    s_add_u32 s73, s72, 24576
    buffer_load_dwordx4 a[200:203], v2, s[32:35], s73 offen sc1
    s_add_u32 s73, s72, 26624
    buffer_load_dwordx4 a[204:207], v2, s[32:35], s73 offen sc1
    s_add_u32 s73, s72, 28672
    buffer_load_dwordx4 a[208:211], v2, s[32:35], s73 offen sc1
    s_add_u32 s73, s72, 30720
    buffer_load_dwordx4 a[212:215], v2, s[32:35], s73 offen sc1
    s_add_u32 s73, s72, 36864
    s_waitcnt vmcnt(11)
    buffer_store_dword v7, v5, s[24:27], s66 offen
    buffer_store_dword v7, v5, s[32:35], s66 offen sc1
    v_mfma_f32_32x32x16_bf16 v[80:95], a[4:7], a[168:171], 0
    buffer_load_dwordx4 a[216:219], v2, s[32:35], s73 offen sc1
    s_add_u32 s73, s72, 38912
    v_mfma_f32_32x32x16_bf16 v[64:79], a[0:3], a[168:171], 0
    s_waitcnt vmcnt(13)
    v_mfma_f32_32x32x16_bf16 v[80:95], a[12:15], a[172:175], v[80:95]
    buffer_load_dwordx4 a[220:223], v2, s[32:35], s73 offen sc1
    s_add_u32 s73, s72, 40960
    v_mfma_f32_32x32x16_bf16 v[64:79], a[8:11], a[172:175], v[64:79]
    s_waitcnt vmcnt(13)
    v_mfma_f32_32x32x16_bf16 v[80:95], a[20:23], a[176:179], v[80:95]
    buffer_load_dwordx4 a[224:227], v2, s[32:35], s73 offen sc1
    s_add_u32 s73, s72, 43008
    v_mfma_f32_32x32x16_bf16 v[64:79], a[16:19], a[176:179], v[64:79]
    s_waitcnt vmcnt(13)
    v_mfma_f32_32x32x16_bf16 v[80:95], a[28:31], a[180:183], v[80:95]
    buffer_load_dwordx4 a[228:231], v2, s[32:35], s73 offen sc1
    s_add_u32 s73, s72, 49152
    v_mfma_f32_32x32x16_bf16 v[64:79], a[24:27], a[180:183], v[64:79]
    s_waitcnt vmcnt(13)
    v_mfma_f32_32x32x16_bf16 v[80:95], a[36:39], a[184:187], v[80:95]
    buffer_load_dwordx4 a[232:235], v2, s[32:35], s73 offen sc1
    s_add_u32 s73, s72, 51200
    v_mfma_f32_32x32x16_bf16 v[64:79], a[32:35], a[184:187], v[64:79]
    s_waitcnt vmcnt(13)
    v_mfma_f32_32x32x16_bf16 v[80:95], a[44:47], a[188:191], v[80:95]
    buffer_load_dwordx4 a[236:239], v2, s[32:35], s73 offen sc1
    s_add_u32 s73, s72, 53248
    v_mfma_f32_32x32x16_bf16 v[64:79], a[40:43], a[188:191], v[64:79]
    s_waitcnt vmcnt(13)
    v_mfma_f32_32x32x16_bf16 v[80:95], a[52:55], a[192:195], v[80:95]
    buffer_load_dwordx4 a[240:243], v2, s[32:35], s73 offen sc1
    s_add_u32 s73, s72, 55296
    v_mfma_f32_32x32x16_bf16 v[64:79], a[48:51], a[192:195], v[64:79]
    s_waitcnt vmcnt(13)
    v_mfma_f32_32x32x16_bf16 v[80:95], a[60:63], a[196:199], v[80:95]
    buffer_load_dwordx4 a[244:247], v2, s[32:35], s73 offen sc1
    s_add_u32 s73, s72, 61440
    v_mfma_f32_32x32x16_bf16 v[64:79], a[56:59], a[196:199], v[64:79]
    s_waitcnt vmcnt(13)
    v_mfma_f32_32x32x16_bf16 v[80:95], a[68:71], a[200:203], v[80:95]
    buffer_load_dwordx4 a[248:251], v2, s[32:35], s73 offen sc1
    s_add_u32 s73, s72, 63488
    v_lshlrev_b32 v96, 16, v246
    v_and_b32 v97, 0xffff0000, v246
    v_mfma_f32_32x32x16_bf16 v[64:79], a[64:67], a[200:203], v[64:79]
    v_lshlrev_b32 v98, 16, v247
    v_and_b32 v99, 0xffff0000, v247
    buffer_load_dword v15, v14, s[24:27], s70 offen sc1
    s_waitcnt vmcnt(14)
    v_mfma_f32_32x32x16_bf16 v[80:95], a[76:79], a[204:207], v[80:95]
    buffer_load_dwordx4 a[252:255], v2, s[32:35], s73 offen sc1
    s_add_u32 s73, s72, 65536
    v_lshlrev_b32 v100, 16, v248
    v_and_b32 v101, 0xffff0000, v248
    v_mfma_f32_32x32x16_bf16 v[64:79], a[72:75], a[204:207], v[64:79]
    v_lshlrev_b32 v102, 16, v249
    v_and_b32 v103, 0xffff0000, v249
    s_waitcnt vmcnt(14)
    v_mfma_f32_32x32x16_bf16 v[80:95], a[84:87], a[208:211], v[80:95]
    buffer_load_dwordx4 a[168:171], v2, s[32:35], s73 offen sc1
    s_add_u32 s73, s72, 67584
    v_lshlrev_b32 v104, 16, v250
    v_and_b32 v105, 0xffff0000, v250
    v_mfma_f32_32x32x16_bf16 v[64:79], a[80:83], a[208:211], v[64:79]
    v_lshlrev_b32 v106, 16, v251
    v_and_b32 v107, 0xffff0000, v251
    s_waitcnt vmcnt(14)
    v_mfma_f32_32x32x16_bf16 v[80:95], a[92:95], a[212:215], v[80:95]
    buffer_load_dwordx4 a[172:175], v2, s[32:35], s73 offen sc1
    s_add_u32 s73, s72, 73728
    v_lshlrev_b32 v108, 16, v252
    v_and_b32 v109, 0xffff0000, v252
    v_mfma_f32_32x32x16_bf16 v[64:79], a[88:91], a[212:215], v[64:79]
    v_lshlrev_b32 v110, 16, v253
    v_and_b32 v111, 0xffff0000, v253
    s_waitcnt vmcnt(12)
    v_mfma_f32_32x32x16_bf16 v[80:95], a[100:103], a[216:219], v[80:95]
    buffer_load_dwordx4 a[176:179], v2, s[32:35], s73 offen sc1
    s_add_u32 s73, s72, 75776
    v_xor_b32 v112, 0, v19
    v_xor_b32 v113, 32, v19
    v_mfma_f32_32x32x16_bf16 v[64:79], a[96:99], a[216:219], v[64:79]
    v_xor_b32 v114, 64, v19
    v_xor_b32 v115, 96, v19
    s_waitcnt vmcnt(12)
    v_mfma_f32_32x32x16_bf16 v[80:95], a[108:111], a[220:223], v[80:95]
    buffer_load_dwordx4 a[180:183], v2, s[32:35], s73 offen sc1
    s_add_u32 s73, s72, 77824
    v_xor_b32 v116, 128, v19
    v_xor_b32 v117, 160, v19
    v_mfma_f32_32x32x16_bf16 v[64:79], a[104:107], a[220:223], v[64:79]
    v_xor_b32 v118, 192, v19
    v_xor_b32 v119, 224, v19
    s_waitcnt vmcnt(12)
    v_mfma_f32_32x32x16_bf16 v[80:95], a[116:119], a[224:227], v[80:95]
    buffer_load_dwordx4 a[184:187], v2, s[32:35], s73 offen sc1
    s_add_u32 s73, s72, 79872
    v_xor_b32 v21, 16, v20
    v_mfma_f32_32x32x16_bf16 v[64:79], a[112:115], a[224:227], v[64:79]
    s_waitcnt vmcnt(12)
    v_mfma_f32_32x32x16_bf16 v[80:95], a[124:127], a[228:231], v[80:95]
    buffer_load_dwordx4 a[188:191], v2, s[32:35], s73 offen sc1
    s_add_u32 s73, s72, 86016
    v_mfma_f32_32x32x16_bf16 v[64:79], a[120:123], a[228:231], v[64:79]
    s_waitcnt vmcnt(12)
    v_mfma_f32_32x32x16_bf16 v[80:95], a[132:135], a[232:235], v[80:95]
    buffer_load_dwordx4 a[192:195], v2, s[32:35], s73 offen sc1
    s_add_u32 s73, s72, 98304
    v_mfma_f32_32x32x16_bf16 v[64:79], a[128:131], a[232:235], v[64:79]
    s_waitcnt vmcnt(8)
    v_cmp_ne_u32 vcc, s41, v15
    s_cbranch_vccnz L_slow_7
L_back_8:
    v_mfma_f32_32x32x16_bf16 v[80:95], a[140:143], a[236:239], v[80:95]
    buffer_load_dwordx4 a[196:199], v2, s[32:35], s73 offen sc1
    s_add_u32 s73, s72, 100352
    v_mfma_f32_32x32x16_bf16 v[64:79], a[136:139], a[236:239], v[64:79]
    v_mfma_f32_32x32x16_bf16 v[80:95], a[148:151], a[240:243], v[80:95]
    buffer_load_dwordx4 a[200:203], v2, s[32:35], s73 offen sc1
    s_add_u32 s73, s72, 102400
    v_mfma_f32_32x32x16_bf16 v[64:79], a[144:147], a[240:243], v[64:79]
    s_barrier
    v_mfma_f32_32x32x16_bf16 v[80:95], a[156:159], a[244:247], v[80:95]
    buffer_load_dwordx4 a[204:207], v2, s[32:35], s73 offen sc1
    s_add_u32 s73, s72, 104448
    ds_read_b64_tr_b16 v[40:41], v8 offset:61440
    ds_read_b64_tr_b16 v[42:43], v8 offset:62464
    v_mfma_f32_32x32x16_bf16 v[64:79], a[152:155], a[244:247], v[64:79]
    ds_read_b64_tr_b16 v[44:45], v9 offset:61440
    ds_read_b64_tr_b16 v[46:47], v9 offset:62464
    v_mfma_f32_32x32x16_bf16 v[80:95], a[164:167], a[248:251], v[80:95]
    buffer_load_dwordx4 a[208:211], v2, s[32:35], s73 offen sc1
    s_add_u32 s73, s72, 106496
    ds_read_b64_tr_b16 v[48:49], v10 offset:32768
    ds_read_b64_tr_b16 v[50:51], v10 offset:33792
    v_mfma_f32_32x32x16_bf16 v[64:79], a[160:163], a[248:251], v[64:79]
    ds_read_b64_tr_b16 v[52:53], v11 offset:32768
    ds_read_b64_tr_b16 v[54:55], v11 offset:33792
    s_waitcnt vmcnt(11)
    s_waitcnt lgkmcnt(4)
    v_mfma_f32_32x32x16_bf16 v[80:95], v[44:47], a[252:255], v[80:95]
    buffer_load_dwordx4 a[212:215], v2, s[32:35], s73 offen sc1
    s_add_u32 s73, s72, 108544
    ds_read_b64_tr_b16 v[56:57], v10 offset:36864
    ds_read_b64_tr_b16 v[58:59], v10 offset:37888
    v_mfma_f32_32x32x16_bf16 v[64:79], v[40:43], a[252:255], v[64:79]
    ds_read_b64_tr_b16 v[60:61], v11 offset:36864
    ds_read_b64_tr_b16 v[62:63], v11 offset:37888
    s_waitcnt vmcnt(11)
    s_waitcnt lgkmcnt(4)
    v_mfma_f32_32x32x16_bf16 v[80:95], v[52:55], a[168:171], v[80:95]
    buffer_load_dwordx4 a[216:219], v2, s[32:35], s73 offen sc1
    s_add_u32 s73, s72, 110592
    ds_read_b64_tr_b16 v[32:33], v10 offset:40960
    ds_read_b64_tr_b16 v[34:35], v10 offset:41984
    v_mfma_f32_32x32x16_bf16 v[64:79], v[48:51], a[168:171], v[64:79]
    ds_read_b64_tr_b16 v[36:37], v11 offset:40960
    ds_read_b64_tr_b16 v[38:39], v11 offset:41984
    s_waitcnt vmcnt(11)
    s_waitcnt lgkmcnt(4)
    v_mfma_f32_32x32x16_bf16 v[80:95], v[60:63], a[172:175], v[80:95]
    buffer_load_dwordx4 a[220:223], v2, s[32:35], s73 offen sc1
    s_add_u32 s73, s72, 112640
    ds_read_b64_tr_b16 v[40:41], v10 offset:45056
    ds_read_b64_tr_b16 v[42:43], v10 offset:46080
    v_mfma_f32_32x32x16_bf16 v[64:79], v[56:59], a[172:175], v[64:79]
    ds_read_b64_tr_b16 v[44:45], v11 offset:45056
    ds_read_b64_tr_b16 v[46:47], v11 offset:46080
    s_waitcnt vmcnt(11)
    s_waitcnt lgkmcnt(4)
    v_mfma_f32_32x32x16_bf16 v[80:95], v[36:39], a[176:179], v[80:95]
    buffer_load_dwordx4 a[224:227], v2, s[32:35], s73 offen sc1
    s_add_u32 s73, s72, 114688
    ds_read_b64_tr_b16 v[48:49], v10 offset:0
    ds_read_b64_tr_b16 v[50:51], v10 offset:1024
    v_mfma_f32_32x32x16_bf16 v[64:79], v[32:35], a[176:179], v[64:79]
    ds_read_b64_tr_b16 v[52:53], v11 offset:0
    ds_read_b64_tr_b16 v[54:55], v11 offset:1024
    buffer_load_dword v15, v14, s[32:35], s69 offen sc1
    s_waitcnt vmcnt(12)
    s_waitcnt lgkmcnt(4)
    v_mfma_f32_32x32x16_bf16 v[80:95], v[44:47], a[180:183], v[80:95]
    buffer_load_dwordx4 a[228:231], v2, s[32:35], s73 offen sc1
    s_add_u32 s73, s72, 116736
    ds_read_b64_tr_b16 v[56:57], v10 offset:4096
    ds_read_b64_tr_b16 v[58:59], v10 offset:5120
    v_mfma_f32_32x32x16_bf16 v[64:79], v[40:43], a[180:183], v[64:79]
    ds_read_b64_tr_b16 v[60:61], v11 offset:4096
    ds_read_b64_tr_b16 v[62:63], v11 offset:5120
    s_waitcnt vmcnt(12)
    s_waitcnt lgkmcnt(4)
    v_mfma_f32_32x32x16_bf16 v[80:95], v[52:55], a[184:187], v[80:95]
    buffer_load_dwordx4 a[232:235], v2, s[32:35], s73 offen sc1
    s_add_u32 s73, s72, 118784
    ds_read_b64_tr_b16 v[32:33], v10 offset:8192
    ds_read_b64_tr_b16 v[34:35], v10 offset:9216
    v_mfma_f32_32x32x16_bf16 v[64:79], v[48:51], a[184:187], v[64:79]
    ds_read_b64_tr_b16 v[36:37], v11 offset:8192
    ds_read_b64_tr_b16 v[38:39], v11 offset:9216
    s_waitcnt vmcnt(12)
    s_waitcnt lgkmcnt(4)
    v_mfma_f32_32x32x16_bf16 v[80:95], v[60:63], a[188:191], v[80:95]
    buffer_load_dwordx4 a[236:239], v2, s[32:35], s73 offen sc1
    s_add_u32 s73, s72, 120832
    ds_read_b64_tr_b16 v[40:41], v10 offset:12288
    ds_read_b64_tr_b16 v[42:43], v10 offset:13312
    v_mfma_f32_32x32x16_bf16 v[64:79], v[56:59], a[188:191], v[64:79]
    ds_read_b64_tr_b16 v[44:45], v11 offset:12288
    ds_read_b64_tr_b16 v[46:47], v11 offset:13312
    s_waitcnt vmcnt(12)
    s_waitcnt lgkmcnt(4)
    v_mfma_f32_32x32x16_bf16 v[80:95], v[36:39], a[192:195], v[80:95]
    buffer_load_dwordx4 a[240:243], v2, s[32:35], s73 offen sc1
    s_add_u32 s73, s72, 122880
    ds_read_b64_tr_b16 v[48:49], v10 offset:49152
    ds_read_b64_tr_b16 v[50:51], v10 offset:50176
    v_mfma_f32_32x32x16_bf16 v[64:79], v[32:35], a[192:195], v[64:79]
    ds_read_b64_tr_b16 v[52:53], v11 offset:49152
    ds_read_b64_tr_b16 v[54:55], v11 offset:50176
    s_waitcnt vmcnt(12)
    s_waitcnt lgkmcnt(4)
    v_mfma_f32_32x32x16_bf16 v[80:95], v[44:47], a[196:199], v[80:95]
    buffer_load_dwordx4 a[244:247], v2, s[32:35], s73 offen sc1
    s_add_u32 s73, s72, 124928
    ds_read_b64_tr_b16 v[56:57], v10 offset:53248
    ds_read_b64_tr_b16 v[58:59], v10 offset:54272
    v_mfma_f32_32x32x16_bf16 v[64:79], v[40:43], a[196:199], v[64:79]
    ds_read_b64_tr_b16 v[60:61], v11 offset:53248
    ds_read_b64_tr_b16 v[62:63], v11 offset:54272
    s_waitcnt vmcnt(12)
    s_waitcnt lgkmcnt(4)
    v_mfma_f32_32x32x16_bf16 v[80:95], v[52:55], a[200:203], v[80:95]
    buffer_load_dwordx4 a[248:251], v2, s[32:35], s73 offen sc1
    s_add_u32 s73, s72, 126976
    ds_read_b64_tr_b16 v[32:33], v10 offset:16384
    ds_read_b64_tr_b16 v[34:35], v10 offset:17408
    v_mfma_f32_32x32x16_bf16 v[64:79], v[48:51], a[200:203], v[64:79]
    ds_read_b64_tr_b16 v[36:37], v11 offset:16384
    ds_read_b64_tr_b16 v[38:39], v11 offset:17408
    s_waitcnt vmcnt(12)
    s_waitcnt lgkmcnt(4)
    v_mfma_f32_32x32x16_bf16 v[80:95], v[60:63], a[204:207], v[80:95]
    buffer_load_dwordx4 a[252:255], v2, s[32:35], s73 offen sc1
    s_add_u32 s73, s72, 129024
    ds_read_b64_tr_b16 v[40:41], v10 offset:20480
    ds_read_b64_tr_b16 v[42:43], v10 offset:21504
    v_mfma_f32_32x32x16_bf16 v[64:79], v[56:59], a[204:207], v[64:79]
    ds_read_b64_tr_b16 v[44:45], v11 offset:20480
    ds_read_b64_tr_b16 v[46:47], v11 offset:21504
    s_waitcnt vmcnt(12)
    s_waitcnt lgkmcnt(4)
    v_mfma_f32_32x32x16_bf16 v[80:95], v[36:39], a[208:211], v[80:95]
    buffer_load_dwordx4 a[168:171], v2, s[32:35], s73 offen sc1
    s_add_u32 s73, s72, 8192
    ds_read_b64_tr_b16 v[48:49], v8 offset:0
    ds_read_b64_tr_b16 v[50:51], v8 offset:1024
    v_mfma_f32_32x32x16_bf16 v[64:79], v[32:35], a[208:211], v[64:79]
    ds_read_b64_tr_b16 v[52:53], v9 offset:0
    ds_read_b64_tr_b16 v[54:55], v9 offset:1024
    s_waitcnt vmcnt(8)
    v_cmp_ne_u32 vcc, s41, v15
    s_cbranch_vccnz L_slow_9
L_back_10:
    s_waitcnt lgkmcnt(4)
    v_mfma_f32_32x32x16_bf16 v[80:95], v[44:47], a[212:215], v[80:95]
    buffer_load_dwordx4 a[172:175], v2, s[32:35], s73 offen sc1
    s_add_u32 s73, s72, 10240
    ds_read_b64_tr_b16 v[56:57], v8 offset:4096
    ds_read_b64_tr_b16 v[58:59], v8 offset:5120
    v_mfma_f32_32x32x16_bf16 v[64:79], v[40:43], a[212:215], v[64:79]
    ds_read_b64_tr_b16 v[60:61], v9 offset:4096
    ds_read_b64_tr_b16 v[62:63], v9 offset:5120
    s_waitcnt lgkmcnt(4)
    v_mfma_f32_32x32x16_bf16 v[80:95], v[52:55], a[216:219], v[80:95]
    buffer_load_dwordx4 a[176:179], v2, s[32:35], s73 offen sc1
    s_add_u32 s73, s72, 20480
    ds_read_b64_tr_b16 v[32:33], v10 offset:57344
    ds_read_b64_tr_b16 v[34:35], v10 offset:58368
    v_mfma_f32_32x32x16_bf16 v[64:79], v[48:51], a[216:219], v[64:79]
    ds_read_b64_tr_b16 v[36:37], v11 offset:57344
    ds_read_b64_tr_b16 v[38:39], v11 offset:58368
    s_waitcnt lgkmcnt(4)
    v_mfma_f32_32x32x16_bf16 v[80:95], v[60:63], a[220:223], v[80:95]
    buffer_load_dwordx4 a[180:183], v2, s[32:35], s73 offen sc1
    s_add_u32 s73, s72, 22528
    ds_read_b64_tr_b16 v[40:41], v10 offset:61440
    ds_read_b64_tr_b16 v[42:43], v10 offset:62464
    v_mfma_f32_32x32x16_bf16 v[64:79], v[56:59], a[220:223], v[64:79]
    ds_read_b64_tr_b16 v[44:45], v11 offset:61440
    ds_read_b64_tr_b16 v[46:47], v11 offset:62464
    s_waitcnt lgkmcnt(4)
    v_mfma_f32_32x32x16_bf16 v[80:95], v[36:39], a[224:227], v[80:95]
    buffer_load_dwordx4 a[184:187], v2, s[32:35], s73 offen sc1
    s_add_u32 s73, s72, 32768
    ds_read_b64_tr_b16 v[48:49], v8 offset:8192
    ds_read_b64_tr_b16 v[50:51], v8 offset:9216
    v_mfma_f32_32x32x16_bf16 v[64:79], v[32:35], a[224:227], v[64:79]
    ds_read_b64_tr_b16 v[52:53], v9 offset:8192
    ds_read_b64_tr_b16 v[54:55], v9 offset:9216
    s_waitcnt vmcnt(11)
    s_waitcnt lgkmcnt(4)
    v_mfma_f32_32x32x16_bf16 v[80:95], v[44:47], a[228:231], v[80:95]
    buffer_load_dwordx4 a[188:191], v2, s[32:35], s73 offen sc1
    s_add_u32 s73, s72, 34816
    ds_read_b64_tr_b16 v[56:57], v8 offset:12288
    ds_read_b64_tr_b16 v[58:59], v8 offset:13312
    v_mfma_f32_32x32x16_bf16 v[64:79], v[40:43], a[228:231], v[64:79]
    ds_read_b64_tr_b16 v[60:61], v9 offset:12288
    ds_read_b64_tr_b16 v[62:63], v9 offset:13312
    s_waitcnt vmcnt(11)
    s_waitcnt lgkmcnt(4)
    v_mfma_f32_32x32x16_bf16 v[80:95], v[52:55], a[232:235], v[80:95]
    buffer_load_dwordx4 a[192:195], v2, s[32:35], s73 offen sc1
    s_add_u32 s73, s72, 45056
    ds_read_b64_tr_b16 v[32:33], v8 offset:16384
    ds_read_b64_tr_b16 v[34:35], v8 offset:17408
    v_mfma_f32_32x32x16_bf16 v[64:79], v[48:51], a[232:235], v[64:79]
    ds_read_b64_tr_b16 v[36:37], v9 offset:16384
    ds_read_b64_tr_b16 v[38:39], v9 offset:17408
    s_waitcnt vmcnt(11)
    s_waitcnt lgkmcnt(4)
    v_mfma_f32_32x32x16_bf16 v[80:95], v[60:63], a[236:239], v[80:95]
    buffer_load_dwordx4 a[196:199], v2, s[32:35], s73 offen sc1
    s_add_u32 s73, s72, 47104
    ds_read_b64_tr_b16 v[40:41], v8 offset:20480
    ds_read_b64_tr_b16 v[42:43], v8 offset:21504
    v_mfma_f32_32x32x16_bf16 v[64:79], v[56:59], a[236:239], v[64:79]
    ds_read_b64_tr_b16 v[44:45], v9 offset:20480
    ds_read_b64_tr_b16 v[46:47], v9 offset:21504
    s_waitcnt vmcnt(11)
    s_waitcnt lgkmcnt(4)
    v_mfma_f32_32x32x16_bf16 v[80:95], v[36:39], a[240:243], v[80:95]
    buffer_load_dwordx4 a[200:203], v2, s[32:35], s73 offen sc1
    s_add_u32 s73, s72, 57344
    ds_read_b64_tr_b16 v[48:49], v12 offset:0
    ds_read_b64_tr_b16 v[50:51], v12 offset:1024
    v_mfma_f32_32x32x16_bf16 v[64:79], v[32:35], a[240:243], v[64:79]
    ds_read_b64_tr_b16 v[52:53], v13 offset:0
    ds_read_b64_tr_b16 v[54:55], v13 offset:1024
    s_waitcnt vmcnt(11)
    s_waitcnt lgkmcnt(4)
    v_mfma_f32_32x32x16_bf16 v[80:95], v[44:47], a[244:247], v[80:95]
    buffer_load_dwordx4 a[204:207], v2, s[32:35], s73 offen sc1
    s_add_u32 s73, s72, 59392
    ds_read_b64_tr_b16 v[56:57], v12 offset:4096
    ds_read_b64_tr_b16 v[58:59], v12 offset:5120
    v_mfma_f32_32x32x16_bf16 v[64:79], v[40:43], a[244:247], v[64:79]
    ds_read_b64_tr_b16 v[60:61], v13 offset:4096
    ds_read_b64_tr_b16 v[62:63], v13 offset:5120
    s_waitcnt vmcnt(11)
    s_waitcnt lgkmcnt(4)
    v_mfma_f32_32x32x16_bf16 v[80:95], v[52:55], a[248:251], v[80:95]
    buffer_load_dwordx4 a[208:211], v2, s[32:35], s73 offen sc1
    s_add_u32 s73, s72, 69632
    ds_read_b64_tr_b16 v[32:33], v8 offset:24576
    ds_read_b64_tr_b16 v[34:35], v8 offset:25600
    v_mfma_f32_32x32x16_bf16 v[64:79], v[48:51], a[248:251], v[64:79]
    ds_read_b64_tr_b16 v[36:37], v9 offset:24576
    ds_read_b64_tr_b16 v[38:39], v9 offset:25600
    s_waitcnt vmcnt(11)
    s_waitcnt lgkmcnt(4)
    v_mfma_f32_32x32x16_bf16 v[80:95], v[60:63], a[252:255], v[80:95]
    buffer_load_dwordx4 a[212:215], v2, s[32:35], s73 offen sc1
    s_add_u32 s73, s72, 71680
    ds_read_b64_tr_b16 v[40:41], v8 offset:28672
    ds_read_b64_tr_b16 v[42:43], v8 offset:29696
    v_mfma_f32_32x32x16_bf16 v[64:79], v[56:59], a[252:255], v[64:79]
    ds_read_b64_tr_b16 v[44:45], v9 offset:28672
    ds_read_b64_tr_b16 v[46:47], v9 offset:29696
    s_barrier
    s_waitcnt vmcnt(11)
    s_waitcnt lgkmcnt(4)
    v_mfma_f32_32x32x16_bf16 v[80:95], v[36:39], a[168:171], v[80:95]
    buffer_load_dwordx4 a[216:219], v2, s[32:35], s73 offen sc1
    s_add_u32 s73, s72, 81920
    ds_read_b64_tr_b16 v[48:49], v8 offset:32768
    ds_read_b64_tr_b16 v[50:51], v8 offset:33792
    v_mfma_f32_32x32x16_bf16 v[64:79], v[32:35], a[168:171], v[64:79]
    ds_read_b64_tr_b16 v[52:53], v9 offset:32768
    ds_read_b64_tr_b16 v[54:55], v9 offset:33792
    s_waitcnt vmcnt(11)
    s_waitcnt lgkmcnt(4)
    v_mfma_f32_32x32x16_bf16 v[80:95], v[44:47], a[172:175], v[80:95]
    buffer_load_dwordx4 a[220:223], v2, s[32:35], s73 offen sc1
    s_add_u32 s73, s72, 83968
    ds_read_b64_tr_b16 v[56:57], v8 offset:36864
    ds_read_b64_tr_b16 v[58:59], v8 offset:37888
    v_mfma_f32_32x32x16_bf16 v[64:79], v[40:43], a[172:175], v[64:79]
    ds_read_b64_tr_b16 v[60:61], v9 offset:36864
    ds_read_b64_tr_b16 v[62:63], v9 offset:37888
    s_waitcnt vmcnt(11)
    s_waitcnt lgkmcnt(4)
    v_mfma_f32_32x32x16_bf16 v[80:95], v[52:55], a[176:179], v[80:95]
    buffer_load_dwordx4 a[224:227], v2, s[32:35], s73 offen sc1
    ds_read_b64_tr_b16 v[32:33], v12 offset:8192
    ds_read_b64_tr_b16 v[34:35], v12 offset:9216
    v_mfma_f32_32x32x16_bf16 v[64:79], v[48:51], a[176:179], v[64:79]
    ds_read_b64_tr_b16 v[36:37], v13 offset:8192
    ds_read_b64_tr_b16 v[38:39], v13 offset:9216
    s_waitcnt vmcnt(11)
    s_waitcnt lgkmcnt(4)
    v_mfma_f32_32x32x16_bf16 v[80:95], v[60:63], a[180:183], v[80:95]
    ds_read_b64_tr_b16 v[40:41], v12 offset:12288
    ds_read_b64_tr_b16 v[42:43], v12 offset:13312
    v_mfma_f32_32x32x16_bf16 v[64:79], v[56:59], a[180:183], v[64:79]
    ds_read_b64_tr_b16 v[44:45], v13 offset:12288
    ds_read_b64_tr_b16 v[46:47], v13 offset:13312
    s_or_b32 s55, s2, s3
    s_cmp_eq_u32 s55, 0
    s_cselect_b32 s55, 0, 2147418112
    v_or_b32 v16, s55, v5
    buffer_store_dword v7, v16, s[32:35], 0 offen offset:0
    s_waitcnt vmcnt(11)
    s_waitcnt lgkmcnt(4)
    v_mfma_f32_32x32x16_bf16 v[80:95], v[36:39], a[184:187], v[80:95]
    ds_read_b64_tr_b16 v[48:49], v8 offset:40960
    ds_read_b64_tr_b16 v[50:51], v8 offset:41984
    v_mfma_f32_32x32x16_bf16 v[64:79], v[32:35], a[184:187], v[64:79]
    ds_read_b64_tr_b16 v[52:53], v9 offset:40960
    ds_read_b64_tr_b16 v[54:55], v9 offset:41984
    s_waitcnt vmcnt(10)
    s_waitcnt lgkmcnt(4)
    v_mfma_f32_32x32x16_bf16 v[80:95], v[44:47], a[188:191], v[80:95]
    ds_read_b64_tr_b16 v[56:57], v8 offset:45056
    ds_read_b64_tr_b16 v[58:59], v8 offset:46080
    v_mfma_f32_32x32x16_bf16 v[64:79], v[40:43], a[188:191], v[64:79]
    ds_read_b64_tr_b16 v[60:61], v9 offset:45056
    ds_read_b64_tr_b16 v[62:63], v9 offset:46080
    s_waitcnt vmcnt(9)
    s_waitcnt lgkmcnt(4)
    v_mfma_f32_32x32x16_bf16 v[80:95], v[52:55], a[192:195], v[80:95]
    ds_read_b64_tr_b16 v[32:33], v8 offset:49152
    ds_read_b64_tr_b16 v[34:35], v8 offset:50176
    v_mfma_f32_32x32x16_bf16 v[64:79], v[48:51], a[192:195], v[64:79]
    ds_read_b64_tr_b16 v[36:37], v9 offset:49152
    ds_read_b64_tr_b16 v[38:39], v9 offset:50176
    s_waitcnt vmcnt(8)
    s_waitcnt lgkmcnt(4)
    v_mfma_f32_32x32x16_bf16 v[80:95], v[60:63], a[196:199], v[80:95]
    ds_read_b64_tr_b16 v[40:41], v8 offset:53248
    ds_read_b64_tr_b16 v[42:43], v8 offset:54272
    v_mfma_f32_32x32x16_bf16 v[64:79], v[56:59], a[196:199], v[64:79]
    ds_read_b64_tr_b16 v[44:45], v9 offset:53248
    ds_read_b64_tr_b16 v[46:47], v9 offset:54272
    s_waitcnt vmcnt(7)
    s_waitcnt lgkmcnt(4)
    v_mfma_f32_32x32x16_bf16 v[80:95], v[36:39], a[200:203], v[80:95]
    ds_read_b64_tr_b16 v[48:49], v12 offset:16384
    ds_read_b64_tr_b16 v[50:51], v12 offset:17408
    v_mfma_f32_32x32x16_bf16 v[64:79], v[32:35], a[200:203], v[64:79]
    ds_read_b64_tr_b16 v[52:53], v13 offset:16384
    ds_read_b64_tr_b16 v[54:55], v13 offset:17408
    s_waitcnt vmcnt(6)
    s_waitcnt lgkmcnt(4)
    v_mfma_f32_32x32x16_bf16 v[80:95], v[44:47], a[204:207], v[80:95]
    ds_read_b64_tr_b16 v[56:57], v12 offset:20480
    ds_read_b64_tr_b16 v[58:59], v12 offset:21504
    v_mfma_f32_32x32x16_bf16 v[64:79], v[40:43], a[204:207], v[64:79]
    ds_read_b64_tr_b16 v[60:61], v13 offset:20480
    ds_read_b64_tr_b16 v[62:63], v13 offset:21504
    s_waitcnt vmcnt(5)
    s_waitcnt lgkmcnt(4)
    v_mfma_f32_32x32x16_bf16 v[80:95], v[52:55], a[208:211], v[80:95]
    ds_read_b64_tr_b16 v[32:33], v8 offset:57344
    ds_read_b64_tr_b16 v[34:35], v8 offset:58368
    v_mfma_f32_32x32x16_bf16 v[64:79], v[48:51], a[208:211], v[64:79]
    ds_read_b64_tr_b16 v[36:37], v9 offset:57344
    ds_read_b64_tr_b16 v[38:39], v9 offset:58368
    s_waitcnt vmcnt(4)
    s_waitcnt lgkmcnt(4)
    v_mfma_f32_32x32x16_bf16 v[80:95], v[60:63], a[212:215], v[80:95]
    ds_read_b64_tr_b16 v[40:41], v10 offset:24576
    ds_read_b64_tr_b16 v[42:43], v10 offset:25600
    v_mfma_f32_32x32x16_bf16 v[64:79], v[56:59], a[212:215], v[64:79]
    ds_read_b64_tr_b16 v[44:45], v11 offset:24576
    ds_read_b64_tr_b16 v[46:47], v11 offset:25600
    s_waitcnt vmcnt(3)
    s_waitcnt lgkmcnt(4)
    v_mfma_f32_32x32x16_bf16 v[80:95], v[36:39], a[216:219], v[80:95]
    ds_read_b64_tr_b16 v[48:49], v10 offset:28672
    ds_read_b64_tr_b16 v[50:51], v10 offset:29696
    v_mfma_f32_32x32x16_bf16 v[64:79], v[32:35], a[216:219], v[64:79]
    ds_read_b64_tr_b16 v[52:53], v11 offset:28672
    ds_read_b64_tr_b16 v[54:55], v11 offset:29696
    s_waitcnt vmcnt(2)
    s_waitcnt lgkmcnt(4)
    v_mfma_f32_32x32x16_bf16 v[80:95], v[44:47], a[220:223], v[80:95]
    s_waitcnt vmcnt(1)
    s_waitcnt lgkmcnt(0)
    v_mfma_f32_32x32x16_bf16 v[80:95], v[52:55], a[224:227], v[80:95]
    v_mfma_f32_32x32x16_bf16 v[64:79], v[40:43], a[220:223], v[64:79]
    v_mfma_f32_32x32x16_bf16 v[64:79], v[48:51], a[224:227], v[64:79]
    s_nop 9
    ds_write_b128 v116, v[80:83]
    ds_write_b128 v117, v[84:87]
    ds_write_b128 v118, v[88:91]
    ds_write_b128 v119, v[92:95]
    ds_write_b128 v112, v[64:67]
    ds_write_b128 v113, v[68:71]
    ds_write_b128 v114, v[72:75]
    ds_write_b128 v115, v[76:79]
    s_waitcnt lgkmcnt(0)
    s_barrier
    ds_read_b128 v[128:131], v20 offset:0
    ds_read_b128 v[132:135], v21 offset:0
    ds_read_b128 v[136:139], v20 offset:16384
    ds_read_b128 v[140:143], v21 offset:16384
    ds_read_b128 v[144:147], v20 offset:2048
    ds_read_b128 v[148:151], v21 offset:2048
    ds_read_b128 v[152:155], v20 offset:18432
    ds_read_b128 v[156:159], v21 offset:18432
    s_waitcnt lgkmcnt(4)
    v_pk_add_f32 v[128:129], v[128:129], v[136:137]
    v_pk_add_f32 v[130:131], v[130:131], v[138:139]
    v_pk_add_f32 v[132:133], v[132:133], v[140:141]
    v_pk_add_f32 v[134:135], v[134:135], v[142:143]
    v_pk_add_f32 v[128:129], v[128:129], v[96:97]
    v_pk_add_f32 v[130:131], v[130:131], v[98:99]
    v_pk_add_f32 v[132:133], v[132:133], v[100:101]
    v_pk_add_f32 v[134:135], v[134:135], v[102:103]
    v_cvt_pk_bf16_f32 v120, v128, v129
    v_cvt_pk_bf16_f32 v121, v130, v131
    v_cvt_pk_bf16_f32 v122, v132, v133
    v_cvt_pk_bf16_f32 v123, v134, v135
    buffer_store_dwordx4 v[120:123], v0, s[28:31], 0 offen
    s_waitcnt lgkmcnt(0)
    v_pk_add_f32 v[144:145], v[144:145], v[152:153]
    v_pk_add_f32 v[146:147], v[146:147], v[154:155]
    v_pk_add_f32 v[148:149], v[148:149], v[156:157]
    v_pk_add_f32 v[150:151], v[150:151], v[158:159]
    v_pk_add_f32 v[144:145], v[144:145], v[104:105]
    v_pk_add_f32 v[146:147], v[146:147], v[106:107]
    v_pk_add_f32 v[148:149], v[148:149], v[108:109]
    v_pk_add_f32 v[150:151], v[150:151], v[110:111]
    v_cvt_pk_bf16_f32 v124, v144, v145
    v_cvt_pk_bf16_f32 v125, v146, v147
    v_cvt_pk_bf16_f32 v126, v148, v149
    v_cvt_pk_bf16_f32 v127, v150, v151
    buffer_store_dwordx4 v[124:127], v0, s[28:31], s90 offen
    s_endpgm
L_typeB:
    s_add_u32 m0, s50, 40960
    s_mul_i32 s54, s77, 1376
    buffer_load_dwordx4 v8, s[4:7], s77 offen lds
    buffer_load_dwordx4 v9, s[4:7], s77 offen offset:1024 lds
    s_mov_b32 s63, s62
    v_cmp_eq_u32 vcc, 0, v1
    v_mov_b32 v222, 2147418112
    v_mov_b32 v166, 0
    v_cndmask_b32 v5, v222, 0, vcc
    s_mov_b32 s27, 0x20000
    s_mov_b32 s26, 2752
    v_lshrrev_b32 v221, 1, v167
    s_add_u32 s53, s0, 4
    s_lshl_b32 s51, s3, 11
    s_add_u32 s51, s51, 98304
    s_and_b32 s91, s36, 1
    s_lshl_b32 s90, s91, 15
    s_lshl_b32 s91, s91, 9
    s_lshl_b32 s52, s3, 10
    v_mul_u32_u24 v222, 2752, v239
    s_lshl_b32 s55, s53, 6
    s_cmp_eq_u32 s38, 7
    s_cselect_b32 s55, 1073709056, s55
    v_add3_u32 v16, v222, v242, s55
    v_add_u32 v17, 20992, v16
    s_lshl_b32 s55, s39, 11
    s_add_u32 s56, s55, 98304
    s_sub_u32 s57, 100352, s55
    v_add_u32 v30, s56, v237
    v_add_u32 v31, s57, v237
    s_lshl_b32 s55, s38, 1
    s_add_u32 s55, s55, s40
    s_lshl_b32 s56, s36, 1
    s_add_u32 s56, s56, s39
    s_lshl_b32 s62, s56, 9
    s_add_u32 s62, s62, 4096
    v_lshlrev_b32 v178, 1, v167
    s_lshl_b32 s57, s55, 7
    s_add_u32 s74, s57, 32768
    s_add_u32 s67, s57, 36864
    s_lshl_b32 s71, s55, 12
    s_add_u32 s71, s71, 65536
    s_lshl_b32 s57, s56, 2
    s_add_u32 s64, s67, s57
    s_lshl_b32 s59, s56, 18
    s_add_u32 s59, s59, 1048576
    s_lshl_b32 s56, s56, 5
    s_add_u32 s56, s56, s55
    s_lshl_b32 s56, s56, 2
    s_add_u32 s65, s56, 45056
    s_add_u32 s75, s56, 40960
    s_add_u32 s66, s56, 49152
    s_and_b32 s42, s2, 7
    s_lshl_b32 s42, s42, 2
    s_lshr_b32 s55, s2, 6
    s_add_u32 s42, s42, s55
    s_lshr_b32 s43, s2, 3
    s_and_b32 s43, s43, 7
    s_xor_b32 s43, s43, 4
    s_lshl_b32 s55, s3, 3
    v_add_lshl_u32 v222, s55, v240, 10
    s_lshl_b32 s55, s43, 7
    v_add3_u32 v6, v222, v242, s55
    v_cmp_gt_u32 vcc, 32, v1
    v_mov_b32 v187, 0x3fb8aa3b
    v_lshlrev_b32 v3, 2, v1
    v_cndmask_b32 v4, 0, -1, vcc
    v_mov_b32 v186, 0x358637bd
    v_mov_b32 v188, 0xb5c1a2a0
    v_mov_b32 v184, 0xbfb17218
    v_mov_b32 v185, 0x3f317218
    v_mov_b32 v170, 0
    v_mov_b32 v171, 0
    v_mov_b32 v174, 0
    v_mov_b32 v175, 0
    v_mov_b32 v248, 0
    v_mov_b32 v249, 0
    v_mov_b32 v252, 0
    v_mov_b32 v253, 0
    v_and_b32 v222, 16, v1
    v_cmp_eq_u32 s[46:47], 0, v222
    s_lshl_b32 s55, s3, 9
    v_add_u32 v254, s55, v3
    v_xor_b32 v255, 512, v254
    s_lshr_b32 s55, s2, 3
    s_mul_i32 s56, s55, 43
    s_mul_i32 s57, s3, 22
    s_add_u32 s56, s56, s57
    s_lshl_b32 s57, s55, 4
    s_cmp_ge_u32 s3, 2
    s_cselect_b32 s56, s57, s56
    s_cselect_b32 s92, s16, s20
    s_cselect_b32 s93, s17, s21
    s_lshl_b32 s56, s56, 10
    s_add_u32 s56, s56, 384
    s_add_u32 s92, s92, s56
    s_addc_u32 s93, s93, 0
    s_lshl_b32 s57, s3, 3
    s_lshr_b32 s94, 1053974, s57
    s_and_b32 s94, s94, 0xff
    s_lshl_b32 s94, s94, 10
    s_sub_u32 s94, s94, 512
    s_max_i32 s94, s94, 0
    s_mov_b32 s95, 0x20000
    v_lshlrev_b32 v177, 10, v1
    s_waitcnt vmcnt(7)
    v_dot2_f32_bf16 v200, v224, v189, 0
    buffer_load_dwordx4 v10, s[4:7], s77 offen offset:2048 lds
    v_dot2_f32_bf16 v202, v224, v224, 0
    v_dot2_f32_bf16 v201, v228, v189, 0
    v_dot2_f32_bf16 v203, v228, v228, 0
    v_dot2_f32_bf16 v200, v225, v189, v200
    v_dot2_f32_bf16 v202, v225, v225, v202
    v_dot2_f32_bf16 v201, v229, v189, v201
    v_dot2_f32_bf16 v203, v229, v229, v203
    v_dot2_f32_bf16 v200, v226, v189, v200
    v_dot2_f32_bf16 v202, v226, v226, v202
    v_dot2_f32_bf16 v201, v230, v189, v201
    buffer_load_dwordx4 v11, s[4:7], s77 offen offset:3072 lds
    s_add_u32 m0, s50, 45056
    v_dot2_f32_bf16 v203, v230, v230, v203
    v_dot2_f32_bf16 v200, v227, v189, v200
    v_dot2_f32_bf16 v202, v227, v227, v202
    v_dot2_f32_bf16 v201, v231, v189, v201
    v_dot2_f32_bf16 v203, v231, v231, v203
    s_nop 2
    v_add_f32_dpp v200, v200, v200 row_ror:8 row_mask:0xf bank_mask:0xf
    v_add_f32_dpp v201, v201, v201 row_ror:8 row_mask:0xf bank_mask:0xf
    v_add_f32_dpp v202, v202, v202 row_ror:8 row_mask:0xf bank_mask:0xf
    buffer_load_dwordx4 v12, s[12:15], s54 offen lds
    v_add_f32_dpp v203, v203, v203 row_ror:8 row_mask:0xf bank_mask:0xf
    v_add_f32_dpp v200, v200, v200 row_ror:4 row_mask:0xf bank_mask:0xf
    v_add_f32_dpp v201, v201, v201 row_ror:4 row_mask:0xf bank_mask:0xf
    v_add_f32_dpp v202, v202, v202 row_ror:4 row_mask:0xf bank_mask:0xf
    v_add_f32_dpp v203, v203, v203 row_ror:4 row_mask:0xf bank_mask:0xf
    v_add_f32_dpp v200, v200, v200 row_ror:2 row_mask:0xf bank_mask:0xf
    v_add_f32_dpp v201, v201, v201 row_ror:2 row_mask:0xf bank_mask:0xf
    v_add_f32_dpp v202, v202, v202 row_ror:2 row_mask:0xf bank_mask:0xf
    v_add_f32_dpp v203, v203, v203 row_ror:2 row_mask:0xf bank_mask:0xf
    v_add_f32_dpp v200, v200, v200 row_ror:1 row_mask:0xf bank_mask:0xf
    buffer_load_dwordx4 v13, s[12:15], s54 offen offset:1024 lds
    s_add_u32 m0, s50, 47104
    v_add_f32_dpp v201, v201, v201 row_ror:1 row_mask:0xf bank_mask:0xf
    v_add_f32_dpp v202, v202, v202 row_ror:1 row_mask:0xf bank_mask:0xf
    v_add_f32_dpp v203, v203, v203 row_ror:1 row_mask:0xf bank_mask:0xf
    v_add_f32_dpp v200, v200, v200 row_bcast:15 row_mask:0xa bank_mask:0xf
    v_add_f32_dpp v201, v201, v201 row_bcast:15 row_mask:0xa bank_mask:0xf
    v_add_f32_dpp v202, v202, v202 row_bcast:15 row_mask:0xa bank_mask:0xf
    v_add_f32_dpp v203, v203, v203 row_bcast:15 row_mask:0xa bank_mask:0xf
    v_add_f32_dpp v200, v200, v200 row_bcast:31 row_mask:0xc bank_mask:0xf
    v_add_f32_dpp v201, v201, v201 row_bcast:31 row_mask:0xc bank_mask:0xf
    buffer_load_dwordx4 v14, s[12:15], s54 offen lds
    v_add_f32_dpp v202, v202, v202 row_bcast:31 row_mask:0xc bank_mask:0xf
    v_add_f32_dpp v203, v203, v203 row_bcast:31 row_mask:0xc bank_mask:0xf
    v_mul_f32 v200, 0x3b000000, v200
    v_mul_f32 v201, 0x3b000000, v201
    v_mul_f32 v202, 0x3b000000, v202
    v_mul_f32 v203, 0x3b000000, v203
    v_fma_f32 v202, -v200, v200, v202
    v_fma_f32 v203, -v201, v201, v203
    v_max_f32 v202, 0, v202
    v_max_f32 v203, 0, v203
    buffer_load_dwordx4 v15, s[12:15], s54 offen offset:1024 lds
    v_cvt_pk_bf16_f32 v204, v202, v203
    v_lshlrev_b32 v205, 16, v204
    v_and_b32 v206, 0xffff0000, v204
    v_add_f32 v205, 0x3727c5ac, v205
    v_add_f32 v206, 0x3727c5ac, v206
    v_cvt_pk_bf16_f32 v204, v205, v206
    v_lshlrev_b32 v205, 16, v204
    v_and_b32 v206, 0xffff0000, v204
    v_sqrt_f32 v205, v205
    v_sqrt_f32 v206, v206
    s_waitcnt lgkmcnt(0)
    s_add_u32 s41, s61, 1540483477
    v_mov_b32 v7, s41
    v_mov_b32 v209, s41
    v_mov_b32 v211, s41
    v_cvt_pk_bf16_f32 v208, v200, v205
    v_cvt_pk_bf16_f32 v210, v201, v206
    buffer_store_dwordx4 v[208:211], v212, s[32:35], s63 offen sc1
    s_waitcnt vmcnt(10)
    s_barrier
    ds_read_b64_tr_b16 v[48:49], v26 offset:0
    ds_read_b64_tr_b16 v[50:51], v26 offset:512
    ds_read_b128 a[0:3], v18 offset:0
    ds_read_b128 a[4:7], v18 offset:8192
    ds_read_b64_tr_b16 v[52:53], v26 offset:2048
    ds_read_b64_tr_b16 v[54:55], v26 offset:2560
    s_waitcnt lgkmcnt(3)
    v_mfma_f32_32x32x16_bf16 v[64:79], v[48:51], a[0:3], 0
    ds_read_b64_tr_b16 v[56:57], v27 offset:0
    ds_read_b64_tr_b16 v[58:59], v27 offset:512
    ds_read_b128 a[8:11], v19 offset:0
    buffer_load_dword v176, v220, s[84:87], 0 offen
    s_add_u32 m0, s50, 73728
    s_mul_i32 s54, s78, 1376
    s_waitcnt lgkmcnt(5)
    v_mfma_f32_32x32x16_bf16 v[80:95], v[48:51], a[4:7], 0
    buffer_load_dwordx4 v8, s[4:7], s78 offen lds
    v_dot2_f32_bf16 v46, v48, v189, 0
    v_dot2_f32_bf16 v46, v49, v189, v46
    s_waitcnt lgkmcnt(3)
    v_mfma_f32_32x32x16_bf16 v[96:111], v[52:55], a[0:3], 0
    ds_read_b128 a[12:15], v19 offset:8192
    ds_read_b64_tr_b16 v[60:61], v27 offset:2048
    ds_read_b64_tr_b16 v[62:63], v27 offset:2560
    buffer_load_dwordx4 v9, s[4:7], s78 offen offset:1024 lds
    v_mfma_f32_32x32x16_bf16 v[112:127], v[52:55], a[4:7], 0
    buffer_load_dwordx4 v10, s[4:7], s78 offen offset:2048 lds
    v_dot2_f32_bf16 v47, v52, v189, 0
    v_dot2_f32_bf16 v47, v53, v189, v47
    s_waitcnt lgkmcnt(3)
    v_mfma_f32_32x32x16_bf16 v[64:79], v[56:59], a[8:11], v[64:79]
    ds_read_b64_tr_b16 v[48:49], v26 offset:16384
    ds_read_b64_tr_b16 v[50:51], v26 offset:16896
    ds_read_b128 a[16:19], v20 offset:0
    buffer_load_dwordx4 v11, s[4:7], s78 offen offset:3072 lds
    s_add_u32 m0, s50, 77824
    s_waitcnt lgkmcnt(5)
    v_mfma_f32_32x32x16_bf16 v[80:95], v[56:59], a[12:15], v[80:95]
    buffer_load_dwordx4 v12, s[12:15], s54 offen lds
    v_dot2_f32_bf16 v46, v58, v189, v46
    v_dot2_f32_bf16 v46, v59, v189, v46
    s_waitcnt lgkmcnt(3)
    v_mfma_f32_32x32x16_bf16 v[96:111], v[60:63], a[8:11], v[96:111]
    ds_read_b128 a[20:23], v20 offset:8192
    ds_read_b64_tr_b16 v[52:53], v26 offset:18432
    ds_read_b64_tr_b16 v[54:55], v26 offset:18944
    buffer_load_dwordx4 v13, s[12:15], s54 offen offset:1024 lds
    s_add_u32 m0, s50, 79872
    v_mfma_f32_32x32x16_bf16 v[112:127], v[60:63], a[12:15], v[112:127]
    buffer_load_dwordx4 v14, s[12:15], s54 offen lds
    v_dot2_f32_bf16 v47, v62, v189, v47
    v_dot2_f32_bf16 v47, v63, v189, v47
    s_waitcnt lgkmcnt(3)
    v_mfma_f32_32x32x16_bf16 v[64:79], v[48:51], a[16:19], v[64:79]
    ds_read_b64_tr_b16 v[56:57], v27 offset:16384
    ds_read_b64_tr_b16 v[58:59], v27 offset:16896
    ds_read_b128 a[24:27], v21 offset:0
    buffer_load_dwordx4 v15, s[12:15], s54 offen offset:1024 lds
    s_waitcnt lgkmcnt(5)
    v_mfma_f32_32x32x16_bf16 v[80:95], v[48:51], a[20:23], v[80:95]
    s_add_u32 s73, s0, s40
    s_lshl_b32 s73, s73, 6
    buffer_load_ushort v247, v221, s[24:27], s73 offen
    v_dot2_f32_bf16 v46, v48, v189, v46
    v_dot2_f32_bf16 v46, v49, v189, v46
    s_waitcnt lgkmcnt(3)
    v_mfma_f32_32x32x16_bf16 v[96:111], v[52:55], a[16:19], v[96:111]
    ds_read_b128 a[28:31], v21 offset:8192
    ds_read_b64_tr_b16 v[60:61], v27 offset:18432
    ds_read_b64_tr_b16 v[62:63], v27 offset:18944
    s_add_u32 s73, s1, s40
    s_lshl_b32 s73, s73, 6
    buffer_load_ushort v251, v221, s[24:27], s73 offen
    v_mfma_f32_32x32x16_bf16 v[112:127], v[52:55], a[20:23], v[112:127]
    s_add_u32 s73, s53, s40
    s_lshl_b32 s73, s73, 6
    buffer_load_ushort v165, v221, s[24:27], s73 offen
    v_dot2_f32_bf16 v47, v52, v189, v47
    v_dot2_f32_bf16 v47, v53, v189, v47
    s_waitcnt lgkmcnt(0)
    s_waitcnt vmcnt(13)
    s_barrier
    v_mfma_f32_32x32x16_bf16 v[64:79], v[56:59], a[24:27], v[64:79]
    ds_read_b64_tr_b16 v[48:49], v26 offset:32768
    ds_read_b64_tr_b16 v[50:51], v26 offset:33280
    ds_read_b128 a[32:35], v18 offset:32768
    v_mfma_f32_32x32x16_bf16 v[80:95], v[56:59], a[28:31], v[80:95]
    s_add_u32 m0, s50, 8192
    s_mul_i32 s54, s79, 1376
    buffer_load_dwordx4 v8, s[4:7], s79 offen lds
    v_dot2_f32_bf16 v46, v58, v189, v46
    v_dot2_f32_bf16 v46, v59, v189, v46
    v_mfma_f32_32x32x16_bf16 v[96:111], v[60:63], a[24:27], v[96:111]
    ds_read_b128 a[36:39], v18 offset:40960
    ds_read_b64_tr_b16 v[52:53], v26 offset:34816
    ds_read_b64_tr_b16 v[54:55], v26 offset:35328
    v_mfma_f32_32x32x16_bf16 v[112:127], v[60:63], a[28:31], v[112:127]
    buffer_load_dwordx4 v9, s[4:7], s79 offen offset:1024 lds
    v_dot2_f32_bf16 v47, v62, v189, v47
    v_dot2_f32_bf16 v47, v63, v189, v47
    s_waitcnt lgkmcnt(3)
    v_mfma_f32_32x32x16_bf16 v[64:79], v[48:51], a[32:35], v[64:79]
    ds_read_b64_tr_b16 v[56:57], v27 offset:32768
    ds_read_b64_tr_b16 v[58:59], v27 offset:33280
    ds_read_b128 a[40:43], v19 offset:32768
    s_waitcnt lgkmcnt(5)
    v_mfma_f32_32x32x16_bf16 v[80:95], v[48:51], a[36:39], v[80:95]
    buffer_load_dwordx4 v10, s[4:7], s79 offen offset:2048 lds
    v_dot2_f32_bf16 v46, v48, v189, v46
    v_dot2_f32_bf16 v46, v49, v189, v46
    s_waitcnt lgkmcnt(3)
    v_mfma_f32_32x32x16_bf16 v[96:111], v[52:55], a[32:35], v[96:111]
    ds_read_b128 a[44:47], v19 offset:40960
    ds_read_b64_tr_b16 v[60:61], v27 offset:34816
    ds_read_b64_tr_b16 v[62:63], v27 offset:35328
    buffer_load_dwordx4 v11, s[4:7], s79 offen offset:3072 lds
    s_add_u32 m0, s50, 12288
    v_mfma_f32_32x32x16_bf16 v[112:127], v[52:55], a[36:39], v[112:127]
    buffer_load_dwordx4 v12, s[12:15], s54 offen lds
    v_dot2_f32_bf16 v47, v52, v189, v47
    v_dot2_f32_bf16 v47, v53, v189, v47
    s_waitcnt lgkmcnt(3)
    v_mfma_f32_32x32x16_bf16 v[64:79], v[56:59], a[40:43], v[64:79]
    ds_read_b64_tr_b16 v[48:49], v26 offset:49152
    ds_read_b64_tr_b16 v[50:51], v26 offset:49664
    ds_read_b128 a[48:51], v20 offset:32768
    s_waitcnt lgkmcnt(5)
    v_mfma_f32_32x32x16_bf16 v[80:95], v[56:59], a[44:47], v[80:95]
    buffer_load_dwordx4 v13, s[12:15], s54 offen offset:1024 lds
    s_add_u32 m0, s50, 14336
    v_dot2_f32_bf16 v46, v58, v189, v46
    v_dot2_f32_bf16 v46, v59, v189, v46
    s_waitcnt lgkmcnt(3)
    v_mfma_f32_32x32x16_bf16 v[96:111], v[60:63], a[40:43], v[96:111]
    ds_read_b128 a[52:55], v20 offset:40960
    ds_read_b64_tr_b16 v[52:53], v26 offset:51200
    ds_read_b64_tr_b16 v[54:55], v26 offset:51712
    v_mfma_f32_32x32x16_bf16 v[112:127], v[60:63], a[44:47], v[112:127]
    buffer_load_dwordx4 v14, s[12:15], s54 offen lds
    v_dot2_f32_bf16 v47, v62, v189, v47
    v_dot2_f32_bf16 v47, v63, v189, v47
    s_waitcnt lgkmcnt(3)
    v_mfma_f32_32x32x16_bf16 v[64:79], v[48:51], a[48:51], v[64:79]
    ds_read_b64_tr_b16 v[56:57], v27 offset:49152
    ds_read_b64_tr_b16 v[58:59], v27 offset:49664
    ds_read_b128 a[56:59], v21 offset:32768
    s_waitcnt lgkmcnt(5)
    v_mfma_f32_32x32x16_bf16 v[80:95], v[48:51], a[52:55], v[80:95]
    buffer_load_dwordx4 v15, s[12:15], s54 offen offset:1024 lds
    s_add_u32 m0, s51, 8192
    s_mul_i32 s54, s45, 1376
    v_dot2_f32_bf16 v46, v48, v189, v46
    v_dot2_f32_bf16 v46, v49, v189, v46
    s_waitcnt lgkmcnt(3)
    v_mfma_f32_32x32x16_bf16 v[96:111], v[52:55], a[48:51], v[96:111]
    ds_read_b128 a[60:63], v21 offset:40960
    ds_read_b64_tr_b16 v[60:61], v27 offset:51200
    ds_read_b64_tr_b16 v[62:63], v27 offset:51712
    buffer_load_dwordx4 v16, s[12:15], s54 offen lds
    v_mfma_f32_32x32x16_bf16 v[112:127], v[52:55], a[52:55], v[112:127]
    buffer_load_dwordx4 v17, s[12:15], s54 offen offset:1024 lds
    v_dot2_f32_bf16 v47, v52, v189, v47
    v_dot2_f32_bf16 v47, v53, v189, v47
    s_waitcnt lgkmcnt(0)
    s_waitcnt vmcnt(13)
    s_barrier
    v_mfma_f32_32x32x16_bf16 v[64:79], v[56:59], a[56:59], v[64:79]
    ds_read_b64_tr_b16 v[48:49], v28 offset:0
    ds_read_b64_tr_b16 v[50:51], v28 offset:512
    ds_read_b128 a[64:67], v22 offset:0
    v_mfma_f32_32x32x16_bf16 v[80:95], v[56:59], a[60:63], v[80:95]
    s_add_u32 m0, s50, 40960
    s_mul_i32 s54, s80, 1376
    buffer_load_dwordx4 v8, s[4:7], s80 offen lds
    v_dot2_f32_bf16 v46, v58, v189, v46
    v_dot2_f32_bf16 v46, v59, v189, v46
    v_mfma_f32_32x32x16_bf16 v[96:111], v[60:63], a[56:59], v[96:111]
    ds_read_b128 a[68:71], v22 offset:8192
    ds_read_b64_tr_b16 v[52:53], v28 offset:2048
    ds_read_b64_tr_b16 v[54:55], v28 offset:2560
    v_mfma_f32_32x32x16_bf16 v[112:127], v[60:63], a[60:63], v[112:127]
    buffer_load_dwordx4 v9, s[4:7], s80 offen offset:1024 lds
    v_dot2_f32_bf16 v47, v62, v189, v47
    v_dot2_f32_bf16 v47, v63, v189, v47
    s_waitcnt lgkmcnt(3)
    v_mfma_f32_32x32x16_bf16 v[64:79], v[48:51], a[64:67], v[64:79]
    ds_read_b64_tr_b16 v[56:57], v29 offset:0
    ds_read_b64_tr_b16 v[58:59], v29 offset:512
    ds_read_b128 a[72:75], v23 offset:0
    s_waitcnt lgkmcnt(5)
    v_mfma_f32_32x32x16_bf16 v[80:95], v[48:51], a[68:71], v[80:95]
    buffer_load_dwordx4 v10, s[4:7], s80 offen offset:2048 lds
    v_dot2_f32_bf16 v46, v48, v189, v46
    v_dot2_f32_bf16 v46, v49, v189, v46
    s_waitcnt lgkmcnt(3)
    v_mfma_f32_32x32x16_bf16 v[96:111], v[52:55], a[64:67], v[96:111]
    ds_read_b128 a[76:79], v23 offset:8192
    ds_read_b64_tr_b16 v[60:61], v29 offset:2048
    ds_read_b64_tr_b16 v[62:63], v29 offset:2560
    buffer_load_dwordx4 v11, s[4:7], s80 offen offset:3072 lds
    s_add_u32 m0, s50, 45056
    v_mfma_f32_32x32x16_bf16 v[112:127], v[52:55], a[68:71], v[112:127]
    buffer_load_dwordx4 v12, s[12:15], s54 offen lds
    v_dot2_f32_bf16 v47, v52, v189, v47
    v_dot2_f32_bf16 v47, v53, v189, v47
    s_waitcnt lgkmcnt(3)
    v_mfma_f32_32x32x16_bf16 v[64:79], v[56:59], a[72:75], v[64:79]
    ds_read_b64_tr_b16 v[48:49], v28 offset:16384
    ds_read_b64_tr_b16 v[50:51], v28 offset:16896
    ds_read_b128 a[80:83], v24 offset:0
    s_waitcnt lgkmcnt(5)
    v_mfma_f32_32x32x16_bf16 v[80:95], v[56:59], a[76:79], v[80:95]
    buffer_load_dwordx4 v13, s[12:15], s54 offen offset:1024 lds
    s_add_u32 m0, s50, 47104
    v_dot2_f32_bf16 v46, v58, v189, v46
    v_dot2_f32_bf16 v46, v59, v189, v46
    s_waitcnt lgkmcnt(3)
    v_mfma_f32_32x32x16_bf16 v[96:111], v[60:63], a[72:75], v[96:111]
    ds_read_b128 a[84:87], v24 offset:8192
    ds_read_b64_tr_b16 v[52:53], v28 offset:18432
    ds_read_b64_tr_b16 v[54:55], v28 offset:18944
    v_mfma_f32_32x32x16_bf16 v[112:127], v[60:63], a[76:79], v[112:127]
    buffer_load_dwordx4 v14, s[12:15], s54 offen lds
    v_dot2_f32_bf16 v47, v62, v189, v47
    v_dot2_f32_bf16 v47, v63, v189, v47
    s_waitcnt lgkmcnt(3)
    v_mfma_f32_32x32x16_bf16 v[64:79], v[48:51], a[80:83], v[64:79]
    ds_read_b64_tr_b16 v[56:57], v29 offset:16384
    ds_read_b64_tr_b16 v[58:59], v29 offset:16896
    ds_read_b128 a[88:91], v25 offset:0
    s_waitcnt lgkmcnt(5)
    v_mfma_f32_32x32x16_bf16 v[80:95], v[48:51], a[84:87], v[80:95]
    buffer_load_dwordx4 v15, s[12:15], s54 offen offset:1024 lds
    s_add_u32 m0, s51, 16384
    s_mul_i32 s54, s77, 1376
    v_dot2_f32_bf16 v46, v48, v189, v46
    v_dot2_f32_bf16 v46, v49, v189, v46
    s_waitcnt lgkmcnt(3)
    v_mfma_f32_32x32x16_bf16 v[96:111], v[52:55], a[80:83], v[96:111]
    ds_read_b128 a[92:95], v25 offset:8192
    ds_read_b64_tr_b16 v[60:61], v29 offset:18432
    ds_read_b64_tr_b16 v[62:63], v29 offset:18944
    buffer_load_dwordx4 v16, s[12:15], s54 offen lds
    v_mfma_f32_32x32x16_bf16 v[112:127], v[52:55], a[84:87], v[112:127]
    buffer_load_dwordx4 v17, s[12:15], s54 offen offset:1024 lds
    v_dot2_f32_bf16 v47, v52, v189, v47
    v_dot2_f32_bf16 v47, v53, v189, v47
    s_waitcnt lgkmcnt(0)
    s_waitcnt vmcnt(12)
    s_barrier
    v_mfma_f32_32x32x16_bf16 v[64:79], v[56:59], a[88:91], v[64:79]
    ds_read_b64_tr_b16 v[48:49], v26 offset:0
    ds_read_b64_tr_b16 v[50:51], v26 offset:512
    ds_read_b128 a[96:99], v18 offset:0
    v_mfma_f32_32x32x16_bf16 v[80:95], v[56:59], a[92:95], v[80:95]
    s_add_u32 m0, s50, 73728
    s_mul_i32 s54, s81, 1376
    buffer_load_dwordx4 v8, s[4:7], s81 offen lds
    v_dot2_f32_bf16 v46, v58, v189, v46
    v_dot2_f32_bf16 v46, v59, v189, v46
    v_mfma_f32_32x32x16_bf16 v[96:111], v[60:63], a[88:91], v[96:111]
    ds_read_b128 a[100:103], v18 offset:8192
    ds_read_b64_tr_b16 v[52:53], v26 offset:2048
    ds_read_b64_tr_b16 v[54:55], v26 offset:2560
    v_mfma_f32_32x32x16_bf16 v[112:127], v[60:63], a[92:95], v[112:127]
    buffer_load_dwordx4 v9, s[4:7], s81 offen offset:1024 lds
    v_dot2_f32_bf16 v47, v62, v189, v47
    v_dot2_f32_bf16 v47, v63, v189, v47
    s_waitcnt lgkmcnt(3)
    v_mfma_f32_32x32x16_bf16 v[64:79], v[48:51], a[96:99], v[64:79]
    ds_read_b64_tr_b16 v[56:57], v27 offset:0
    ds_read_b64_tr_b16 v[58:59], v27 offset:512
    ds_read_b128 a[104:107], v19 offset:0
    s_waitcnt lgkmcnt(5)
    v_mfma_f32_32x32x16_bf16 v[80:95], v[48:51], a[100:103], v[80:95]
    buffer_load_dwordx4 v10, s[4:7], s81 offen offset:2048 lds
    v_dot2_f32_bf16 v46, v48, v189, v46
    v_dot2_f32_bf16 v46, v49, v189, v46
    s_waitcnt lgkmcnt(3)
    v_mfma_f32_32x32x16_bf16 v[96:111], v[52:55], a[96:99], v[96:111]
    ds_read_b128 a[108:111], v19 offset:8192
    ds_read_b64_tr_b16 v[60:61], v27 offset:2048
    ds_read_b64_tr_b16 v[62:63], v27 offset:2560
    buffer_load_dwordx4 v11, s[4:7], s81 offen offset:3072 lds
    s_add_u32 m0, s50, 77824
    v_mfma_f32_32x32x16_bf16 v[112:127], v[52:55], a[100:103], v[112:127]
    buffer_load_dwordx4 v12, s[12:15], s54 offen lds
    v_dot2_f32_bf16 v47, v52, v189, v47
    v_dot2_f32_bf16 v47, v53, v189, v47
    s_waitcnt lgkmcnt(3)
    v_mfma_f32_32x32x16_bf16 v[64:79], v[56:59], a[104:107], v[64:79]
    ds_read_b64_tr_b16 v[48:49], v26 offset:16384
    ds_read_b64_tr_b16 v[50:51], v26 offset:16896
    ds_read_b128 a[112:115], v20 offset:0
    s_waitcnt lgkmcnt(5)
    v_mfma_f32_32x32x16_bf16 v[80:95], v[56:59], a[108:111], v[80:95]
    buffer_load_dwordx4 v13, s[12:15], s54 offen offset:1024 lds
    s_add_u32 m0, s50, 79872
    v_dot2_f32_bf16 v46, v58, v189, v46
    v_dot2_f32_bf16 v46, v59, v189, v46
    s_waitcnt lgkmcnt(3)
    v_mfma_f32_32x32x16_bf16 v[96:111], v[60:63], a[104:107], v[96:111]
    ds_read_b128 a[116:119], v20 offset:8192
    ds_read_b64_tr_b16 v[52:53], v26 offset:18432
    ds_read_b64_tr_b16 v[54:55], v26 offset:18944
    v_mfma_f32_32x32x16_bf16 v[112:127], v[60:63], a[108:111], v[112:127]
    buffer_load_dwordx4 v14, s[12:15], s54 offen lds
    v_dot2_f32_bf16 v47, v62, v189, v47
    v_dot2_f32_bf16 v47, v63, v189, v47
    s_waitcnt lgkmcnt(3)
    v_mfma_f32_32x32x16_bf16 v[64:79], v[48:51], a[112:115], v[64:79]
    ds_read_b64_tr_b16 v[56:57], v27 offset:16384
    ds_read_b64_tr_b16 v[58:59], v27 offset:16896
    ds_read_b128 a[120:123], v21 offset:0
    s_waitcnt lgkmcnt(5)
    v_mfma_f32_32x32x16_bf16 v[80:95], v[48:51], a[116:119], v[80:95]
    buffer_load_dwordx4 v15, s[12:15], s54 offen offset:1024 lds
    s_add_u32 m0, s51, 24576
    s_mul_i32 s54, s78, 1376
    v_dot2_f32_bf16 v46, v48, v189, v46
    v_dot2_f32_bf16 v46, v49, v189, v46
    s_waitcnt lgkmcnt(3)
    v_mfma_f32_32x32x16_bf16 v[96:111], v[52:55], a[112:115], v[96:111]
    ds_read_b128 a[124:127], v21 offset:8192
    ds_read_b64_tr_b16 v[60:61], v27 offset:18432
    ds_read_b64_tr_b16 v[62:63], v27 offset:18944
    buffer_load_dwordx4 v16, s[12:15], s54 offen lds
    v_mfma_f32_32x32x16_bf16 v[112:127], v[52:55], a[116:119], v[112:127]
    buffer_load_dwordx4 v17, s[12:15], s54 offen offset:1024 lds
    v_dot2_f32_bf16 v47, v52, v189, v47
    v_dot2_f32_bf16 v47, v53, v189, v47
    s_waitcnt lgkmcnt(0)
    s_waitcnt vmcnt(12)
    s_barrier
    v_mfma_f32_32x32x16_bf16 v[64:79], v[56:59], a[120:123], v[64:79]
    ds_read_b64_tr_b16 v[48:49], v26 offset:32768
    ds_read_b64_tr_b16 v[50:51], v26 offset:33280
    ds_read_b128 a[128:131], v18 offset:32768
    v_mfma_f32_32x32x16_bf16 v[80:95], v[56:59], a[124:127], v[80:95]
    buffer_load_dwordx2 v[160:161], v178, s[32:35], s62 offen sc1
    buffer_load_dwordx2 v[162:163], v178, s[32:35], s62 offen offset:256 sc1
    s_add_u32 m0, s50, 8192
    s_mul_i32 s54, s82, 1376
    v_dot2_f32_bf16 v46, v58, v189, v46
    v_dot2_f32_bf16 v46, v59, v189, v46
    v_mfma_f32_32x32x16_bf16 v[96:111], v[60:63], a[120:123], v[96:111]
    ds_read_b128 a[132:135], v18 offset:40960
    ds_read_b64_tr_b16 v[52:53], v26 offset:34816
    ds_read_b64_tr_b16 v[54:55], v26 offset:35328
    v_mfma_f32_32x32x16_bf16 v[112:127], v[60:63], a[124:127], v[112:127]
    buffer_load_dwordx4 v8, s[4:7], s82 offen lds
    v_dot2_f32_bf16 v47, v62, v189, v47
    v_dot2_f32_bf16 v47, v63, v189, v47
    s_waitcnt lgkmcnt(3)
    v_mfma_f32_32x32x16_bf16 v[64:79], v[48:51], a[128:131], v[64:79]
    ds_read_b64_tr_b16 v[56:57], v27 offset:32768
    ds_read_b64_tr_b16 v[58:59], v27 offset:33280
    ds_read_b128 a[136:139], v19 offset:32768
    s_waitcnt lgkmcnt(5)
    v_mfma_f32_32x32x16_bf16 v[80:95], v[48:51], a[132:135], v[80:95]
    buffer_load_dwordx4 v9, s[4:7], s82 offen offset:1024 lds
    s_waitcnt lgkmcnt(3)
    v_mfma_f32_32x32x16_bf16 v[96:111], v[52:55], a[128:131], v[96:111]
    ds_read_b128 a[140:143], v19 offset:40960
    ds_read_b64_tr_b16 v[60:61], v27 offset:34816
    ds_read_b64_tr_b16 v[62:63], v27 offset:35328
    buffer_load_dwordx4 v10, s[4:7], s82 offen offset:2048 lds
    v_mfma_f32_32x32x16_bf16 v[112:127], v[52:55], a[132:135], v[112:127]
    buffer_load_dwordx4 v11, s[4:7], s82 offen offset:3072 lds
    s_add_u32 m0, s50, 12288
    v_dot2_f32_bf16 v46, v48, v189, v46
    v_dot2_f32_bf16 v47, v52, v189, v47
    v_dot2_f32_bf16 v46, v49, v189, v46
    v_dot2_f32_bf16 v47, v53, v189, v47
    v_dot2_f32_bf16 v46, v50, v189, v46
    v_dot2_f32_bf16 v47, v54, v189, v47
    v_dot2_f32_bf16 v46, v51, v189, v46
    v_dot2_f32_bf16 v47, v55, v189, v47
    s_waitcnt lgkmcnt(3)
    v_mfma_f32_32x32x16_bf16 v[64:79], v[56:59], a[136:139], v[64:79]
    ds_read_b64_tr_b16 v[48:49], v26 offset:49152
    ds_read_b64_tr_b16 v[50:51], v26 offset:49664
    ds_read_b128 a[144:147], v20 offset:32768
    s_waitcnt lgkmcnt(5)
    v_mfma_f32_32x32x16_bf16 v[80:95], v[56:59], a[140:143], v[80:95]
    buffer_load_dwordx4 v12, s[12:15], s54 offen lds
    s_waitcnt lgkmcnt(3)
    v_mfma_f32_32x32x16_bf16 v[96:111], v[60:63], a[136:139], v[96:111]
    ds_read_b128 a[148:151], v20 offset:40960
    ds_read_b64_tr_b16 v[52:53], v26 offset:51200
    ds_read_b64_tr_b16 v[54:55], v26 offset:51712
    v_mfma_f32_32x32x16_bf16 v[112:127], v[60:63], a[140:143], v[112:127]
    buffer_load_dwordx4 v13, s[12:15], s54 offen offset:1024 lds
    s_add_u32 m0, s50, 14336
    s_waitcnt lgkmcnt(3)
    v_mfma_f32_32x32x16_bf16 v[64:79], v[48:51], a[144:147], v[64:79]
    ds_read_b64_tr_b16 v[56:57], v27 offset:49152
    ds_read_b64_tr_b16 v[58:59], v27 offset:49664
    ds_read_b128 a[152:155], v21 offset:32768
    s_waitcnt lgkmcnt(5)
    v_mfma_f32_32x32x16_bf16 v[80:95], v[48:51], a[148:151], v[80:95]
    buffer_load_dwordx4 v14, s[12:15], s54 offen lds
    s_waitcnt lgkmcnt(3)
    v_mfma_f32_32x32x16_bf16 v[96:111], v[52:55], a[144:147], v[96:111]
    ds_read_b128 a[156:159], v21 offset:40960
    ds_read_b64_tr_b16 v[60:61], v27 offset:51200
    ds_read_b64_tr_b16 v[62:63], v27 offset:51712
    buffer_load_dwordx4 v15, s[12:15], s54 offen offset:1024 lds
    s_add_u32 m0, s51, 32768
    s_mul_i32 s54, s79, 1376
    v_mfma_f32_32x32x16_bf16 v[112:127], v[52:55], a[148:151], v[112:127]
    buffer_load_dwordx4 v16, s[12:15], s54 offen lds
    v_dot2_f32_bf16 v46, v48, v189, v46
    v_dot2_f32_bf16 v47, v52, v189, v47
    v_dot2_f32_bf16 v46, v49, v189, v46
    v_dot2_f32_bf16 v47, v53, v189, v47
    v_dot2_f32_bf16 v46, v50, v189, v46
    v_dot2_f32_bf16 v47, v54, v189, v47
    v_dot2_f32_bf16 v46, v51, v189, v46
    v_dot2_f32_bf16 v47, v55, v189, v47
    s_waitcnt lgkmcnt(0)
    s_waitcnt vmcnt(13)
    s_barrier
    v_mfma_f32_32x32x16_bf16 v[64:79], v[56:59], a[152:155], v[64:79]
    ds_read_b64_tr_b16 v[48:49], v28 offset:0
    ds_read_b64_tr_b16 v[50:51], v28 offset:512
    ds_read_b128 a[160:163], v22 offset:0
    v_mfma_f32_32x32x16_bf16 v[80:95], v[56:59], a[156:159], v[80:95]
    buffer_load_dwordx4 v17, s[12:15], s54 offen offset:1024 lds
    s_add_u32 m0, s51, 40960
    s_mul_i32 s54, s80, 1376
    s_waitcnt vmcnt(10)
    v_xor_b32 v222, s41, v161
    v_xor_b32 v223, s41, v163
    v_or_b32 v222, v222, v223
    v_mfma_f32_32x32x16_bf16 v[96:111], v[60:63], a[152:155], v[96:111]
    ds_read_b128 a[164:167], v22 offset:8192
    ds_read_b64_tr_b16 v[52:53], v28 offset:2048
    ds_read_b64_tr_b16 v[54:55], v28 offset:2560
    v_mfma_f32_32x32x16_bf16 v[112:127], v[60:63], a[156:159], v[112:127]
    buffer_load_dwordx4 v16, s[12:15], s54 offen lds
    v_cmp_ne_u32 vcc, 0, v222
    s_cbranch_vccnz L_slow_11
L_back_12:
    v_and_b32 v222, 0xffff, v160
    s_waitcnt lgkmcnt(3)
    v_mfma_f32_32x32x16_bf16 v[64:79], v[48:51], a[160:163], v[64:79]
    ds_read_b64_tr_b16 v[56:57], v29 offset:0
    ds_read_b64_tr_b16 v[58:59], v29 offset:512
    ds_read_b128 a[168:171], v23 offset:0
    s_waitcnt lgkmcnt(5)
    v_mfma_f32_32x32x16_bf16 v[80:95], v[48:51], a[164:167], v[80:95]
    buffer_load_dwordx4 v17, s[12:15], s54 offen offset:1024 lds
    s_add_u32 m0, s50, 40960
    s_mul_i32 s54, s83, 1376
    v_and_b32 v223, 0xffff0000, v160
    v_xor_b32 v222, 0x8000, v222
    v_rcp_f32 v180, v223
    s_waitcnt lgkmcnt(3)
    v_mfma_f32_32x32x16_bf16 v[96:111], v[52:55], a[160:163], v[96:111]
    ds_read_b128 a[172:175], v23 offset:8192
    ds_read_b64_tr_b16 v[60:61], v29 offset:2048
    ds_read_b64_tr_b16 v[62:63], v29 offset:2560
    buffer_load_dwordx4 v8, s[4:7], s83 offen lds
    v_mfma_f32_32x32x16_bf16 v[112:127], v[52:55], a[164:167], v[112:127]
    buffer_load_dwordx4 v9, s[4:7], s83 offen offset:1024 lds
    v_lshl_or_b32 v222, v222, 16, v222
    v_lshrrev_b32 v223, 16, v160
    v_and_b32 v168, v4, v222
    v_dot2_f32_bf16 v46, v48, v189, v46
    v_dot2_f32_bf16 v47, v52, v189, v47
    v_dot2_f32_bf16 v46, v49, v189, v46
    v_dot2_f32_bf16 v47, v53, v189, v47
    v_dot2_f32_bf16 v46, v50, v189, v46
    v_dot2_f32_bf16 v47, v54, v189, v47
    v_dot2_f32_bf16 v46, v51, v189, v46
    v_dot2_f32_bf16 v47, v55, v189, v47
    s_waitcnt lgkmcnt(3)
    v_mfma_f32_32x32x16_bf16 v[64:79], v[56:59], a[168:171], v[64:79]
    ds_read_b64_tr_b16 v[48:49], v28 offset:16384
    ds_read_b64_tr_b16 v[50:51], v28 offset:16896
    ds_read_b128 a[176:179], v24 offset:0
    s_waitcnt lgkmcnt(5)
    v_mfma_f32_32x32x16_bf16 v[80:95], v[56:59], a[172:175], v[80:95]
    buffer_load_dwordx4 v10, s[4:7], s83 offen offset:2048 lds
    v_and_b32 v169, v4, v223
    v_mul_f32 v181, v187, v180
    v_and_b32 v222, 0xffff, v162
    s_waitcnt lgkmcnt(3)
    v_mfma_f32_32x32x16_bf16 v[96:111], v[60:63], a[168:171], v[96:111]
    ds_read_b128 a[180:183], v24 offset:8192
    ds_read_b64_tr_b16 v[52:53], v28 offset:18432
    ds_read_b64_tr_b16 v[54:55], v28 offset:18944
    v_mfma_f32_32x32x16_bf16 v[112:127], v[60:63], a[172:175], v[112:127]
    buffer_load_dwordx4 v11, s[4:7], s83 offen offset:3072 lds
    s_add_u32 m0, s50, 45056
    v_and_b32 v223, 0xffff0000, v162
    v_xor_b32 v222, 0x8000, v222
    v_rcp_f32 v182, v223
    s_waitcnt lgkmcnt(3)
    v_mfma_f32_32x32x16_bf16 v[64:79], v[48:51], a[176:179], v[64:79]
    ds_read_b64_tr_b16 v[56:57], v29 offset:16384
    ds_read_b64_tr_b16 v[58:59], v29 offset:16896
    ds_read_b128 a[184:187], v25 offset:0
    s_waitcnt lgkmcnt(5)
    v_mfma_f32_32x32x16_bf16 v[80:95], v[48:51], a[180:183], v[80:95]
    buffer_load_dwordx4 v12, s[12:15], s54 offen lds
    v_lshl_or_b32 v222, v222, 16, v222
    v_lshrrev_b32 v223, 16, v162
    v_and_b32 v172, v4, v222
    s_waitcnt lgkmcnt(3)
    v_mfma_f32_32x32x16_bf16 v[96:111], v[52:55], a[176:179], v[96:111]
    ds_read_b128 a[188:191], v25 offset:8192
    ds_read_b64_tr_b16 v[60:61], v29 offset:18432
    ds_read_b64_tr_b16 v[62:63], v29 offset:18944
    buffer_load_dwordx4 v13, s[12:15], s54 offen offset:1024 lds
    s_add_u32 m0, s50, 47104
    v_mfma_f32_32x32x16_bf16 v[112:127], v[52:55], a[180:183], v[112:127]
    buffer_load_dwordx4 v14, s[12:15], s54 offen lds
    v_and_b32 v173, v4, v223
    v_mul_f32 v183, v187, v182
    s_add_u32 s24, s32, 12288
    s_addc_u32 s25, s33, 0
    v_dot2_f32_bf16 v46, v48, v189, v46
    v_dot2_f32_bf16 v47, v52, v189, v47
    v_dot2_f32_bf16 v46, v49, v189, v46
    v_dot2_f32_bf16 v47, v53, v189, v47
    v_dot2_f32_bf16 v46, v50, v189, v46
    v_dot2_f32_bf16 v47, v54, v189, v47
    v_dot2_f32_bf16 v46, v51, v189, v46
    v_dot2_f32_bf16 v47, v55, v189, v47
    s_waitcnt lgkmcnt(0)
    s_waitcnt vmcnt(11)
    s_barrier
    v_mfma_f32_32x32x16_bf16 v[64:79], v[56:59], a[184:187], v[64:79]
    ds_read_b64_tr_b16 v[48:49], v26 offset:0
    ds_read_b64_tr_b16 v[50:51], v26 offset:512
    ds_read_b128 a[192:195], v18 offset:0
    v_mfma_f32_32x32x16_bf16 v[80:95], v[56:59], a[188:191], v[80:95]
    buffer_load_dwordx4 v15, s[12:15], s54 offen offset:1024 lds
    s_add_u32 m0, s51, 49152
    s_mul_i32 s54, s81, 1376
    s_mov_b32 s26, 33542144
    v_mov_b32 v161, v165
    v_mov_b32 v162, 0
    v_mfma_f32_32x32x16_bf16 v[96:111], v[60:63], a[184:187], v[96:111]
    ds_read_b128 a[196:199], v18 offset:8192
    ds_read_b64_tr_b16 v[52:53], v26 offset:2048
    ds_read_b64_tr_b16 v[54:55], v26 offset:2560
    v_mfma_f32_32x32x16_bf16 v[112:127], v[60:63], a[188:191], v[112:127]
    buffer_load_dwordx4 v16, s[12:15], s54 offen lds
    v_mov_b32 v163, 0
    v_bfe_u32 v224, v1, 2, 2
    v_lshrrev_b32 v226, 5, v1
    s_waitcnt lgkmcnt(3)
    v_mfma_f32_32x32x16_bf16 v[64:79], v[48:51], a[192:195], v[64:79]
    ds_read_b64_tr_b16 v[56:57], v27 offset:0
    ds_read_b64_tr_b16 v[58:59], v27 offset:512
    ds_read_b128 a[200:203], v19 offset:0
    s_waitcnt lgkmcnt(5)
    v_mfma_f32_32x32x16_bf16 v[80:95], v[48:51], a[196:199], v[80:95]
    buffer_load_dwordx4 v17, s[12:15], s54 offen offset:1024 lds
    s_add_u32 m0, s51, 57344
    s_mul_i32 s54, s82, 1376
    v_lshl_add_u32 v225, v226, 2, v224
    v_lshlrev_b32 v225, 7, v225
    v_bfe_u32 v226, v1, 4, 1
    s_waitcnt lgkmcnt(3)
    v_mfma_f32_32x32x16_bf16 v[96:111], v[52:55], a[192:195], v[96:111]
    ds_read_b128 a[204:207], v19 offset:8192
    ds_read_b64_tr_b16 v[60:61], v27 offset:2048
    ds_read_b64_tr_b16 v[62:63], v27 offset:2560
    buffer_load_dwordx4 v16, s[12:15], s54 offen lds
    v_mfma_f32_32x32x16_bf16 v[112:127], v[52:55], a[196:199], v[112:127]
    buffer_load_dwordx4 v17, s[12:15], s54 offen offset:1024 lds
    s_add_u32 m0, s51, 0
    s_mul_i32 s54, s83, 1376
    v_lshl_add_u32 v225, v226, 5, v225
    v_and_b32 v226, 3, v1
    v_lshl_add_u32 v225, v226, 3, v225
    v_dot2_f32_bf16 v46, v48, v189, v46
    v_dot2_f32_bf16 v47, v52, v189, v47
    v_dot2_f32_bf16 v46, v49, v189, v46
    v_dot2_f32_bf16 v47, v53, v189, v47
    v_dot2_f32_bf16 v46, v50, v189, v46
    v_dot2_f32_bf16 v47, v54, v189, v47
    v_dot2_f32_bf16 v46, v51, v189, v46
    v_dot2_f32_bf16 v47, v55, v189, v47
    s_waitcnt lgkmcnt(3)
    v_mfma_f32_32x32x16_bf16 v[64:79], v[56:59], a[200:203], v[64:79]
    ds_read_b64_tr_b16 v[48:49], v26 offset:16384
    ds_read_b64_tr_b16 v[50:51], v26 offset:16896
    ds_read_b128 a[208:211], v20 offset:0
    s_waitcnt lgkmcnt(5)
    v_mfma_f32_32x32x16_bf16 v[80:95], v[56:59], a[204:207], v[80:95]
    buffer_load_dwordx4 v16, s[12:15], s54 offen lds
    s_lshl_b32 s55, s40, 11
    s_add_u32 s55, s55, 8192
    v_lshrrev_b32 v224, 1, v224
    s_waitcnt lgkmcnt(3)
    v_mfma_f32_32x32x16_bf16 v[96:111], v[60:63], a[200:203], v[96:111]
    ds_read_b128 a[212:215], v20 offset:8192
    ds_read_b64_tr_b16 v[52:53], v26 offset:18432
    ds_read_b64_tr_b16 v[54:55], v26 offset:18944
    v_mfma_f32_32x32x16_bf16 v[112:127], v[60:63], a[204:207], v[112:127]
    buffer_load_dwordx4 v17, s[12:15], s54 offen offset:1024 lds
    s_add_u32 m0, s52, 73728
    s_mov_b32 s54, 0
    v_xor_b32 v224, s40, v224
    v_lshl_add_u32 v225, v224, 6, v225
    v_add_u32 v8, s55, v225
    s_waitcnt lgkmcnt(3)
    v_mfma_f32_32x32x16_bf16 v[64:79], v[48:51], a[208:211], v[64:79]
    ds_read_b64_tr_b16 v[56:57], v27 offset:16384
    ds_read_b64_tr_b16 v[58:59], v27 offset:16896
    ds_read_b128 a[216:219], v21 offset:0
    s_waitcnt lgkmcnt(5)
    v_mfma_f32_32x32x16_bf16 v[80:95], v[48:51], a[212:215], v[80:95]
    buffer_load_dwordx4 v6, s[20:23], s54 offen lds
    s_add_u32 m0, s52, 77824
    s_mov_b32 s54, 32768
    v_xor_b32 v9, 64, v8
    v_add_u32 v10, 65536, v8
    v_add_u32 v11, 65536, v9
    s_waitcnt lgkmcnt(3)
    v_mfma_f32_32x32x16_bf16 v[96:111], v[52:55], a[208:211], v[96:111]
    ds_read_b128 a[220:223], v21 offset:8192
    ds_read_b64_tr_b16 v[60:61], v27 offset:18432
    ds_read_b64_tr_b16 v[62:63], v27 offset:18944
    buffer_load_dwordx4 v6, s[20:23], s54 offen lds
    s_add_u32 m0, s52, 81920
    s_mov_b32 s54, 65536
    v_mfma_f32_32x32x16_bf16 v[112:127], v[52:55], a[212:215], v[112:127]
    buffer_load_dwordx4 v6, s[20:23], s54 offen lds
    s_add_u32 m0, s52, 86016
    s_mov_b32 s54, 98304
    v_add_u32 v12, 131072, v8
    v_add_u32 v13, 131072, v9
    v_dot2_f32_bf16 v46, v48, v189, v46
    v_dot2_f32_bf16 v47, v52, v189, v47
    v_dot2_f32_bf16 v46, v49, v189, v46
    v_dot2_f32_bf16 v47, v53, v189, v47
    v_dot2_f32_bf16 v46, v50, v189, v46
    v_dot2_f32_bf16 v47, v54, v189, v47
    v_dot2_f32_bf16 v46, v51, v189, v46
    v_dot2_f32_bf16 v47, v55, v189, v47
    s_waitcnt lgkmcnt(0)
    s_waitcnt vmcnt(9)
    s_barrier
    v_mfma_f32_32x32x16_bf16 v[64:79], v[56:59], a[216:219], v[64:79]
    ds_read_b64_tr_b16 v[48:49], v26 offset:32768
    ds_read_b64_tr_b16 v[50:51], v26 offset:33280
    ds_read_b128 a[224:227], v18 offset:32768
    v_mfma_f32_32x32x16_bf16 v[80:95], v[56:59], a[220:223], v[80:95]
    buffer_load_dwordx4 v6, s[20:23], s54 offen lds
    s_add_u32 m0, s52, 90112
    s_mov_b32 s54, 196608
    v_mfma_f32_32x32x16_bf16 v[96:111], v[60:63], a[216:219], v[96:111]
    ds_read_b128 a[228:231], v18 offset:40960
    ds_read_b64_tr_b16 v[52:53], v26 offset:34816
    ds_read_b64_tr_b16 v[54:55], v26 offset:35328
    v_mfma_f32_32x32x16_bf16 v[112:127], v[60:63], a[220:223], v[112:127]
    buffer_load_dwordx4 v6, s[20:23], s54 offen lds
    s_add_u32 m0, s52, 94208
    s_mov_b32 s54, 229376
    s_waitcnt lgkmcnt(3)
    v_mfma_f32_32x32x16_bf16 v[64:79], v[48:51], a[224:227], v[64:79]
    ds_read_b64_tr_b16 v[56:57], v27 offset:32768
    ds_read_b64_tr_b16 v[58:59], v27 offset:33280
    ds_read_b128 a[232:235], v19 offset:32768
    s_waitcnt lgkmcnt(5)
    v_mfma_f32_32x32x16_bf16 v[80:95], v[48:51], a[228:231], v[80:95]
    buffer_load_dwordx4 v6, s[20:23], s54 offen lds
    s_add_u32 m0, s52, 8192
    s_mov_b32 s54, 262144
    s_waitcnt lgkmcnt(3)
    v_mfma_f32_32x32x16_bf16 v[96:111], v[52:55], a[224:227], v[96:111]
    ds_read_b128 a[236:239], v19 offset:40960
    ds_read_b64_tr_b16 v[60:61], v27 offset:34816
    ds_read_b64_tr_b16 v[62:63], v27 offset:35328
    buffer_load_dwordx4 v6, s[20:23], s54 offen lds
    s_add_u32 m0, s52, 12288
    s_mov_b32 s54, 294912
    v_mfma_f32_32x32x16_bf16 v[112:127], v[52:55], a[228:231], v[112:127]
    buffer_load_dwordx4 v6, s[20:23], s54 offen lds
    s_add_u32 m0, s52, 16384
    s_mov_b32 s54, 393216
    v_dot2_f32_bf16 v46, v48, v189, v46
    v_dot2_f32_bf16 v47, v52, v189, v47
    v_dot2_f32_bf16 v46, v49, v189, v46
    v_dot2_f32_bf16 v47, v53, v189, v47
    v_dot2_f32_bf16 v46, v50, v189, v46
    v_dot2_f32_bf16 v47, v54, v189, v47
    v_dot2_f32_bf16 v46, v51, v189, v46
    v_dot2_f32_bf16 v47, v55, v189, v47
    s_waitcnt lgkmcnt(3)
    v_mfma_f32_32x32x16_bf16 v[64:79], v[56:59], a[232:235], v[64:79]
    ds_read_b64_tr_b16 v[48:49], v26 offset:49152
    ds_read_b64_tr_b16 v[50:51], v26 offset:49664
    ds_read_b128 a[240:243], v20 offset:32768
    s_waitcnt lgkmcnt(5)
    v_mfma_f32_32x32x16_bf16 v[80:95], v[56:59], a[236:239], v[80:95]
    buffer_load_dwordx4 v6, s[20:23], s54 offen lds
    s_add_u32 m0, s52, 20480
    s_mov_b32 s54, 425984
    s_waitcnt lgkmcnt(3)
    v_mfma_f32_32x32x16_bf16 v[96:111], v[60:63], a[232:235], v[96:111]
    ds_read_b128 a[244:247], v20 offset:40960
    ds_read_b64_tr_b16 v[52:53], v26 offset:51200
    ds_read_b64_tr_b16 v[54:55], v26 offset:51712
    v_mfma_f32_32x32x16_bf16 v[112:127], v[60:63], a[236:239], v[112:127]
    buffer_load_dwordx4 v6, s[20:23], s54 offen lds
    s_add_u32 m0, s52, 24576
    s_mov_b32 s54, 458752
    s_waitcnt lgkmcnt(0)
    v_dot2_f32_bf16 v46, v48, v189, v46
    v_dot2_f32_bf16 v47, v52, v189, v47
    v_dot2_f32_bf16 v46, v49, v189, v46
    v_dot2_f32_bf16 v47, v53, v189, v47
    v_dot2_f32_bf16 v46, v50, v189, v46
    v_dot2_f32_bf16 v47, v54, v189, v47
    v_dot2_f32_bf16 v46, v51, v189, v46
    v_dot2_f32_bf16 v47, v55, v189, v47
    v_mfma_f32_32x32x16_bf16 v[64:79], v[48:51], a[240:243], v[64:79]
    ds_read_b64_tr_b16 v[56:57], v27 offset:49152
    ds_read_b64_tr_b16 v[58:59], v27 offset:49664
    ds_read_b128 a[248:251], v21 offset:32768
    v_mfma_f32_32x32x16_bf16 v[80:95], v[48:51], a[244:247], v[80:95]
    ds_read_b128 a[252:255], v21 offset:40960
    ds_read_b64_tr_b16 v[60:61], v27 offset:51200
    ds_read_b64_tr_b16 v[62:63], v27 offset:51712
    s_nop 0
    v_mov_b32 v37, v46
    v_mov_b32 v41, v47
    s_nop 0
    v_permlane32_swap_b32 v37, v46
    v_permlane32_swap_b32 v41, v47
    v_add_f32 v36, v37, v46
    v_add_f32 v40, v41, v47
    v_mfma_f32_32x32x16_bf16 v[96:111], v[52:55], a[240:243], v[96:111]
    ds_write_b32 v254, v36 offset:1024
    ds_write_b32 v254, v40 offset:1280
    v_mfma_f32_32x32x16_bf16 v[112:127], v[52:55], a[244:247], v[112:127]
    s_waitcnt lgkmcnt(0)
    s_barrier
    v_mfma_f32_32x32x16_bf16 v[64:79], v[56:59], a[248:251], v[64:79]
    ds_read_b32 v37, v255 offset:1024
    ds_read_b32 v41, v255 offset:1280
    buffer_load_dwordx4 v6, s[20:23], s54 offen lds
    s_add_u32 m0, s52, 28672
    s_mov_b32 s54, 491520
    v_mfma_f32_32x32x16_bf16 v[80:95], v[56:59], a[252:255], v[80:95]
    s_waitcnt lgkmcnt(0)
    v_add_f32 v36, v36, v37
    v_cvt_pk_bf16_f32 v37, v36, v36
    v_and_b32 v37, 0xffff0000, v37
    v_sub_f32 v38, v36, v37
    v_cvt_pk_bf16_f32 v246, v37, v38
    v_mfma_f32_32x32x16_bf16 v[96:111], v[60:63], a[248:251], v[96:111]
    v_add_f32 v40, v40, v41
    v_cvt_pk_bf16_f32 v41, v40, v40
    v_and_b32 v41, 0xffff0000, v41
    v_sub_f32 v42, v40, v41
    v_cvt_pk_bf16_f32 v250, v41, v42
    v_mfma_f32_32x32x16_bf16 v[112:127], v[60:63], a[252:255], v[112:127]
    buffer_load_dwordx4 v6, s[20:23], s54 offen lds
    s_add_u32 m0, s52, 32768
    s_mov_b32 s54, 589824
    v_mfma_f32_32x32x16_bf16 v[64:79], v[246:249], v[168:171], v[64:79]
    v_mfma_f32_32x32x16_bf16 v[80:95], v[246:249], v[172:175], v[80:95]
    v_mfma_f32_32x32x16_bf16 v[96:111], v[250:253], v[168:171], v[96:111]
    v_mfma_f32_32x32x16_bf16 v[112:127], v[250:253], v[172:175], v[112:127]
    s_add_u32 s58, s0, s40
    s_lshl_b32 s58, s58, 11
    s_add_u32 s58, s58, s59
    s_nop 5
    v_pk_mul_f32 v[222:223], v[64:65], v[180:181] op_sel:[0,1] op_sel_hi:[1,1]
    buffer_load_dwordx4 v6, s[20:23], s54 offen lds
    s_add_u32 m0, s52, 36864
    s_mov_b32 s54, 622592
    v_pk_mul_f32 v[224:225], v[66:67], v[180:181] op_sel:[0,1] op_sel_hi:[1,1]
    v_pk_mul_f32 v[226:227], v[68:69], v[180:181] op_sel:[0,1] op_sel_hi:[1,1]
    v_pk_mul_f32 v[228:229], v[70:71], v[180:181] op_sel:[0,1] op_sel_hi:[1,1]
    v_exp_f32 v230, v222
    v_exp_f32 v231, v223
    v_exp_f32 v232, v224
    v_exp_f32 v233, v225
    v_exp_f32 v234, v226
    v_exp_f32 v235, v227
    v_exp_f32 v236, v228
    v_exp_f32 v237, v229
    buffer_load_dwordx4 v6, s[20:23], s54 offen lds
    v_pk_add_f32 v[230:231], v[230:231], 1.0 op_sel_hi:[1,0]
    v_pk_add_f32 v[232:233], v[232:233], 1.0 op_sel_hi:[1,0]
    v_pk_add_f32 v[234:235], v[234:235], 1.0 op_sel_hi:[1,0]
    v_pk_add_f32 v[236:237], v[236:237], 1.0 op_sel_hi:[1,0]
    v_pk_fma_f32 v[230:231], v[230:231], v[230:231], 1.0 op_sel_hi:[1,1,0]
    v_pk_fma_f32 v[232:233], v[232:233], v[232:233], 1.0 op_sel_hi:[1,1,0]
    v_pk_fma_f32 v[234:235], v[234:235], v[234:235], 1.0 op_sel_hi:[1,1,0]
    v_pk_fma_f32 v[236:237], v[236:237], v[236:237], 1.0 op_sel_hi:[1,1,0]
    v_rcp_f32 v230, v230
    v_rcp_f32 v231, v231
    v_rcp_f32 v232, v232
    v_rcp_f32 v233, v233
    v_rcp_f32 v234, v234
    v_rcp_f32 v235, v235
    buffer_load_dword v176, v177, s[92:95], 0 offen
    s_add_u32 m0, s52, 40960
    s_mov_b32 s54, 655360
    v_rcp_f32 v236, v236
    buffer_load_dwordx4 v6, s[20:23], s54 offen lds
    s_add_u32 m0, s52, 45056
    s_mov_b32 s54, 688128
    v_rcp_f32 v237, v237
    v_pk_fma_f32 v[230:231], v[230:231], v[184:185], v[184:185] op_sel:[0,0,1] op_sel_hi:[1,0,1]
    v_pk_fma_f32 v[232:233], v[232:233], v[184:185], v[184:185] op_sel:[0,0,1] op_sel_hi:[1,0,1]
    v_pk_fma_f32 v[234:235], v[234:235], v[184:185], v[184:185] op_sel:[0,0,1] op_sel_hi:[1,0,1]
    v_pk_fma_f32 v[236:237], v[236:237], v[184:185], v[184:185] op_sel:[0,0,1] op_sel_hi:[1,0,1]
    v_pk_mul_f32 v[222:223], v[222:223], v[230:231]
    v_pk_mul_f32 v[224:225], v[224:225], v[232:233]
    v_pk_mul_f32 v[226:227], v[226:227], v[234:235]
    v_pk_mul_f32 v[228:229], v[228:229], v[236:237]
    v_cvt_pk_bf16_f32 v238, v222, v223
    v_cvt_pk_bf16_f32 v239, v224, v225
    v_cvt_pk_bf16_f32 v240, v226, v227
    v_cvt_pk_bf16_f32 v241, v228, v229
    buffer_store_dwordx4 v[238:241], v2, s[32:35], s58 offen sc1
    v_pk_mul_f32 v[222:223], v[72:73], v[180:181] op_sel:[0,1] op_sel_hi:[1,1]
    v_pk_mul_f32 v[224:225], v[74:75], v[180:181] op_sel:[0,1] op_sel_hi:[1,1]
    v_pk_mul_f32 v[226:227], v[76:77], v[180:181] op_sel:[0,1] op_sel_hi:[1,1]
    v_pk_mul_f32 v[228:229], v[78:79], v[180:181] op_sel:[0,1] op_sel_hi:[1,1]
    v_exp_f32 v230, v222
    v_exp_f32 v231, v223
    v_exp_f32 v232, v224
    v_exp_f32 v233, v225
    v_exp_f32 v234, v226
    v_exp_f32 v235, v227
    v_exp_f32 v236, v228
    v_exp_f32 v237, v229
    buffer_load_dwordx4 v6, s[20:23], s54 offen lds
    s_add_u32 m0, s52, 49152
    s_mov_b32 s54, 786432
    v_pk_add_f32 v[230:231], v[230:231], 1.0 op_sel_hi:[1,0]
    v_pk_add_f32 v[232:233], v[232:233], 1.0 op_sel_hi:[1,0]
    v_pk_add_f32 v[234:235], v[234:235], 1.0 op_sel_hi:[1,0]
    v_pk_add_f32 v[236:237], v[236:237], 1.0 op_sel_hi:[1,0]
    v_pk_fma_f32 v[230:231], v[230:231], v[230:231], 1.0 op_sel_hi:[1,1,0]
    v_pk_fma_f32 v[232:233], v[232:233], v[232:233], 1.0 op_sel_hi:[1,1,0]
    v_pk_fma_f32 v[234:235], v[234:235], v[234:235], 1.0 op_sel_hi:[1,1,0]
    v_pk_fma_f32 v[236:237], v[236:237], v[236:237], 1.0 op_sel_hi:[1,1,0]
    v_rcp_f32 v230, v230
    v_rcp_f32 v231, v231
    v_rcp_f32 v232, v232
    v_rcp_f32 v233, v233
    v_rcp_f32 v234, v234
    buffer_load_dwordx4 v6, s[20:23], s54 offen lds
    s_add_u32 m0, s52, 53248
    s_mov_b32 s54, 819200
    v_rcp_f32 v235, v235
    v_rcp_f32 v236, v236
    v_rcp_f32 v237, v237
    v_pk_fma_f32 v[230:231], v[230:231], v[184:185], v[184:185] op_sel:[0,0,1] op_sel_hi:[1,0,1]
    v_pk_fma_f32 v[232:233], v[232:233], v[184:185], v[184:185] op_sel:[0,0,1] op_sel_hi:[1,0,1]
    v_pk_fma_f32 v[234:235], v[234:235], v[184:185], v[184:185] op_sel:[0,0,1] op_sel_hi:[1,0,1]
    v_pk_fma_f32 v[236:237], v[236:237], v[184:185], v[184:185] op_sel:[0,0,1] op_sel_hi:[1,0,1]
    v_pk_mul_f32 v[222:223], v[222:223], v[230:231]
    v_pk_mul_f32 v[224:225], v[224:225], v[232:233]
    v_pk_mul_f32 v[226:227], v[226:227], v[234:235]
    v_pk_mul_f32 v[228:229], v[228:229], v[236:237]
    v_cvt_pk_bf16_f32 v242, v222, v223
    v_cvt_pk_bf16_f32 v243, v224, v225
    v_cvt_pk_bf16_f32 v244, v226, v227
    v_cvt_pk_bf16_f32 v245, v228, v229
    buffer_load_dwordx4 v6, s[20:23], s54 offen lds
    s_add_u32 m0, s52, 57344
    s_mov_b32 s54, 851968
    buffer_store_dwordx4 v[242:245], v2, s[32:35], s58 offen offset:1024 sc1
    s_add_u32 s58, s0, s40
    s_lshl_b32 s58, s58, 11
    s_add_u32 s58, s58, s59
    s_add_u32 s58, s58, 131072
    v_pk_mul_f32 v[222:223], v[80:81], v[182:183] op_sel:[0,1] op_sel_hi:[1,1]
    v_pk_mul_f32 v[224:225], v[82:83], v[182:183] op_sel:[0,1] op_sel_hi:[1,1]
    v_pk_mul_f32 v[226:227], v[84:85], v[182:183] op_sel:[0,1] op_sel_hi:[1,1]
    v_pk_mul_f32 v[228:229], v[86:87], v[182:183] op_sel:[0,1] op_sel_hi:[1,1]
    v_exp_f32 v230, v222
    v_exp_f32 v231, v223
    v_exp_f32 v232, v224
    v_exp_f32 v233, v225
    v_exp_f32 v234, v226
    v_exp_f32 v235, v227
    buffer_load_dwordx4 v6, s[20:23], s54 offen lds
    s_add_u32 m0, s52, 61440
    s_mov_b32 s54, 884736
    v_exp_f32 v236, v228
    v_exp_f32 v237, v229
    v_pk_add_f32 v[230:231], v[230:231], 1.0 op_sel_hi:[1,0]
    v_pk_add_f32 v[232:233], v[232:233], 1.0 op_sel_hi:[1,0]
    v_pk_add_f32 v[234:235], v[234:235], 1.0 op_sel_hi:[1,0]
    v_pk_add_f32 v[236:237], v[236:237], 1.0 op_sel_hi:[1,0]
    v_pk_fma_f32 v[230:231], v[230:231], v[230:231], 1.0 op_sel_hi:[1,1,0]
    v_pk_fma_f32 v[232:233], v[232:233], v[232:233], 1.0 op_sel_hi:[1,1,0]
    v_pk_fma_f32 v[234:235], v[234:235], v[234:235], 1.0 op_sel_hi:[1,1,0]
    v_pk_fma_f32 v[236:237], v[236:237], v[236:237], 1.0 op_sel_hi:[1,1,0]
    v_rcp_f32 v230, v230
    v_rcp_f32 v231, v231
    v_rcp_f32 v232, v232
    buffer_load_dwordx4 v6, s[20:23], s54 offen lds
    s_add_u32 m0, s52, 65536
    s_mov_b32 s54, 983040
    v_rcp_f32 v233, v233
    v_rcp_f32 v234, v234
    v_rcp_f32 v235, v235
    v_rcp_f32 v236, v236
    v_rcp_f32 v237, v237
    v_pk_fma_f32 v[230:231], v[230:231], v[184:185], v[184:185] op_sel:[0,0,1] op_sel_hi:[1,0,1]
    v_pk_fma_f32 v[232:233], v[232:233], v[184:185], v[184:185] op_sel:[0,0,1] op_sel_hi:[1,0,1]
    v_pk_fma_f32 v[234:235], v[234:235], v[184:185], v[184:185] op_sel:[0,0,1] op_sel_hi:[1,0,1]
    v_pk_fma_f32 v[236:237], v[236:237], v[184:185], v[184:185] op_sel:[0,0,1] op_sel_hi:[1,0,1]
    v_pk_mul_f32 v[222:223], v[222:223], v[230:231]
    v_pk_mul_f32 v[224:225], v[224:225], v[232:233]
    v_pk_mul_f32 v[226:227], v[226:227], v[234:235]
    v_pk_mul_f32 v[228:229], v[228:229], v[236:237]
    buffer_load_dwordx4 v6, s[20:23], s54 offen lds
    s_add_u32 m0, s52, 69632
    s_mov_b32 s54, 1015808
    v_cvt_pk_bf16_f32 v238, v222, v223
    v_cvt_pk_bf16_f32 v239, v224, v225
    v_cvt_pk_bf16_f32 v240, v226, v227
    v_cvt_pk_bf16_f32 v241, v228, v229
    buffer_store_dwordx4 v[238:241], v2, s[32:35], s58 offen sc1
    v_pk_mul_f32 v[222:223], v[88:89], v[182:183] op_sel:[0,1] op_sel_hi:[1,1]
    v_pk_mul_f32 v[224:225], v[90:91], v[182:183] op_sel:[0,1] op_sel_hi:[1,1]
    v_pk_mul_f32 v[226:227], v[92:93], v[182:183] op_sel:[0,1] op_sel_hi:[1,1]
    v_pk_mul_f32 v[228:229], v[94:95], v[182:183] op_sel:[0,1] op_sel_hi:[1,1]
    v_exp_f32 v230, v222
    v_exp_f32 v231, v223
    v_exp_f32 v232, v224
    v_exp_f32 v233, v225
    v_exp_f32 v234, v226
    v_exp_f32 v235, v227
    v_exp_f32 v236, v228
    v_exp_f32 v237, v229
    buffer_load_dwordx4 v6, s[20:23], s54 offen lds
    v_pk_add_f32 v[230:231], v[230:231], 1.0 op_sel_hi:[1,0]
    v_pk_add_f32 v[232:233], v[232:233], 1.0 op_sel_hi:[1,0]
    v_pk_add_f32 v[234:235], v[234:235], 1.0 op_sel_hi:[1,0]
    v_pk_add_f32 v[236:237], v[236:237], 1.0 op_sel_hi:[1,0]
    v_pk_fma_f32 v[230:231], v[230:231], v[230:231], 1.0 op_sel_hi:[1,1,0]
    v_pk_fma_f32 v[232:233], v[232:233], v[232:233], 1.0 op_sel_hi:[1,1,0]
    v_pk_fma_f32 v[234:235], v[234:235], v[234:235], 1.0 op_sel_hi:[1,1,0]
    v_pk_fma_f32 v[236:237], v[236:237], v[236:237], 1.0 op_sel_hi:[1,1,0]
    v_rcp_f32 v230, v230
    v_rcp_f32 v231, v231
    v_rcp_f32 v232, v232
    v_rcp_f32 v233, v233
    v_rcp_f32 v234, v234
    v_rcp_f32 v235, v235
    v_rcp_f32 v236, v236
    v_rcp_f32 v237, v237
    v_pk_fma_f32 v[230:231], v[230:231], v[184:185], v[184:185] op_sel:[0,0,1] op_sel_hi:[1,0,1]
    v_pk_fma_f32 v[232:233], v[232:233], v[184:185], v[184:185] op_sel:[0,0,1] op_sel_hi:[1,0,1]
    v_pk_fma_f32 v[234:235], v[234:235], v[184:185], v[184:185] op_sel:[0,0,1] op_sel_hi:[1,0,1]
    v_pk_fma_f32 v[236:237], v[236:237], v[184:185], v[184:185] op_sel:[0,0,1] op_sel_hi:[1,0,1]
    v_pk_mul_f32 v[222:223], v[222:223], v[230:231]
    v_pk_mul_f32 v[224:225], v[224:225], v[232:233]
    v_pk_mul_f32 v[226:227], v[226:227], v[234:235]
    v_pk_mul_f32 v[228:229], v[228:229], v[236:237]
    v_cvt_pk_bf16_f32 v242, v222, v223
    v_cvt_pk_bf16_f32 v243, v224, v225
    v_cvt_pk_bf16_f32 v244, v226, v227
    v_cvt_pk_bf16_f32 v245, v228, v229
    buffer_store_dwordx4 v[242:245], v2, s[32:35], s58 offen offset:1024 sc1
    s_add_u32 s58, s1, s40
    s_lshl_b32 s58, s58, 11
    s_add_u32 s58, s58, s59
    v_pk_mul_f32 v[222:223], v[96:97], v[180:181] op_sel:[0,1] op_sel_hi:[1,1]
    v_pk_mul_f32 v[224:225], v[98:99], v[180:181] op_sel:[0,1] op_sel_hi:[1,1]
    v_pk_mul_f32 v[226:227], v[100:101], v[180:181] op_sel:[0,1] op_sel_hi:[1,1]
    v_pk_mul_f32 v[228:229], v[102:103], v[180:181] op_sel:[0,1] op_sel_hi:[1,1]
    v_exp_f32 v230, v222
    v_exp_f32 v231, v223
    v_exp_f32 v232, v224
    v_exp_f32 v233, v225
    v_exp_f32 v234, v226
    v_exp_f32 v235, v227
    v_exp_f32 v236, v228
    v_exp_f32 v237, v229
    v_pk_add_f32 v[230:231], v[230:231], 1.0 op_sel_hi:[1,0]
    v_pk_add_f32 v[232:233], v[232:233], 1.0 op_sel_hi:[1,0]
    v_pk_add_f32 v[234:235], v[234:235], 1.0 op_sel_hi:[1,0]
    v_pk_add_f32 v[236:237], v[236:237], 1.0 op_sel_hi:[1,0]
    v_pk_fma_f32 v[230:231], v[230:231], v[230:231], 1.0 op_sel_hi:[1,1,0]
    v_pk_fma_f32 v[232:233], v[232:233], v[232:233], 1.0 op_sel_hi:[1,1,0]
    v_pk_fma_f32 v[234:235], v[234:235], v[234:235], 1.0 op_sel_hi:[1,1,0]
    v_pk_fma_f32 v[236:237], v[236:237], v[236:237], 1.0 op_sel_hi:[1,1,0]
    v_rcp_f32 v230, v230
    v_rcp_f32 v231, v231
    v_rcp_f32 v232, v232
    v_rcp_f32 v233, v233
    v_rcp_f32 v234, v234
    v_rcp_f32 v235, v235
    v_rcp_f32 v236, v236
    v_rcp_f32 v237, v237
    v_pk_fma_f32 v[230:231], v[230:231], v[184:185], v[184:185] op_sel:[0,0,1] op_sel_hi:[1,0,1]
    v_pk_fma_f32 v[232:233], v[232:233], v[184:185], v[184:185] op_sel:[0,0,1] op_sel_hi:[1,0,1]
    v_pk_fma_f32 v[234:235], v[234:235], v[184:185], v[184:185] op_sel:[0,0,1] op_sel_hi:[1,0,1]
    v_pk_fma_f32 v[236:237], v[236:237], v[184:185], v[184:185] op_sel:[0,0,1] op_sel_hi:[1,0,1]
    v_pk_mul_f32 v[222:223], v[222:223], v[230:231]
    v_pk_mul_f32 v[224:225], v[224:225], v[232:233]
    v_pk_mul_f32 v[226:227], v[226:227], v[234:235]
    v_pk_mul_f32 v[228:229], v[228:229], v[236:237]
    v_cvt_pk_bf16_f32 v238, v222, v223
    v_cvt_pk_bf16_f32 v239, v224, v225
    v_cvt_pk_bf16_f32 v240, v226, v227
    v_cvt_pk_bf16_f32 v241, v228, v229
    buffer_store_dwordx4 v[238:241], v2, s[32:35], s58 offen sc1
    v_pk_mul_f32 v[222:223], v[104:105], v[180:181] op_sel:[0,1] op_sel_hi:[1,1]
    v_pk_mul_f32 v[224:225], v[106:107], v[180:181] op_sel:[0,1] op_sel_hi:[1,1]
    v_pk_mul_f32 v[226:227], v[108:109], v[180:181] op_sel:[0,1] op_sel_hi:[1,1]
    v_pk_mul_f32 v[228:229], v[110:111], v[180:181] op_sel:[0,1] op_sel_hi:[1,1]
    v_exp_f32 v230, v222
    v_exp_f32 v231, v223
    v_exp_f32 v232, v224
    v_exp_f32 v233, v225
    v_exp_f32 v234, v226
    v_exp_f32 v235, v227
    v_exp_f32 v236, v228
    v_exp_f32 v237, v229
    v_pk_add_f32 v[230:231], v[230:231], 1.0 op_sel_hi:[1,0]
    v_pk_add_f32 v[232:233], v[232:233], 1.0 op_sel_hi:[1,0]
    v_pk_add_f32 v[234:235], v[234:235], 1.0 op_sel_hi:[1,0]
    v_pk_add_f32 v[236:237], v[236:237], 1.0 op_sel_hi:[1,0]
    v_pk_fma_f32 v[230:231], v[230:231], v[230:231], 1.0 op_sel_hi:[1,1,0]
    v_pk_fma_f32 v[232:233], v[232:233], v[232:233], 1.0 op_sel_hi:[1,1,0]
    v_pk_fma_f32 v[234:235], v[234:235], v[234:235], 1.0 op_sel_hi:[1,1,0]
    v_pk_fma_f32 v[236:237], v[236:237], v[236:237], 1.0 op_sel_hi:[1,1,0]
    v_rcp_f32 v230, v230
    v_rcp_f32 v231, v231
    v_rcp_f32 v232, v232
    v_rcp_f32 v233, v233
    v_rcp_f32 v234, v234
    v_rcp_f32 v235, v235
    v_rcp_f32 v236, v236
    v_rcp_f32 v237, v237
    v_pk_fma_f32 v[230:231], v[230:231], v[184:185], v[184:185] op_sel:[0,0,1] op_sel_hi:[1,0,1]
    v_pk_fma_f32 v[232:233], v[232:233], v[184:185], v[184:185] op_sel:[0,0,1] op_sel_hi:[1,0,1]
    v_pk_fma_f32 v[234:235], v[234:235], v[184:185], v[184:185] op_sel:[0,0,1] op_sel_hi:[1,0,1]
    v_pk_fma_f32 v[236:237], v[236:237], v[184:185], v[184:185] op_sel:[0,0,1] op_sel_hi:[1,0,1]
    v_pk_mul_f32 v[222:223], v[222:223], v[230:231]
    v_pk_mul_f32 v[224:225], v[224:225], v[232:233]
    v_pk_mul_f32 v[226:227], v[226:227], v[234:235]
    v_pk_mul_f32 v[228:229], v[228:229], v[236:237]
    v_cvt_pk_bf16_f32 v242, v222, v223
    v_cvt_pk_bf16_f32 v243, v224, v225
    v_cvt_pk_bf16_f32 v244, v226, v227
    v_cvt_pk_bf16_f32 v245, v228, v229
    buffer_store_dwordx4 v[242:245], v2, s[32:35], s58 offen offset:1024 sc1
    s_add_u32 s58, s1, s40
    s_lshl_b32 s58, s58, 11
    s_add_u32 s58, s58, s59
    s_add_u32 s58, s58, 131072
    v_pk_mul_f32 v[222:223], v[112:113], v[182:183] op_sel:[0,1] op_sel_hi:[1,1]
    v_pk_mul_f32 v[224:225], v[114:115], v[182:183] op_sel:[0,1] op_sel_hi:[1,1]
    v_pk_mul_f32 v[226:227], v[116:117], v[182:183] op_sel:[0,1] op_sel_hi:[1,1]
    v_pk_mul_f32 v[228:229], v[118:119], v[182:183] op_sel:[0,1] op_sel_hi:[1,1]
    v_exp_f32 v230, v222
    v_exp_f32 v231, v223
    v_exp_f32 v232, v224
    v_exp_f32 v233, v225
    v_exp_f32 v234, v226
    v_exp_f32 v235, v227
    v_exp_f32 v236, v228
    v_exp_f32 v237, v229
    v_pk_add_f32 v[230:231], v[230:231], 1.0 op_sel_hi:[1,0]
    v_pk_add_f32 v[232:233], v[232:233], 1.0 op_sel_hi:[1,0]
    v_pk_add_f32 v[234:235], v[234:235], 1.0 op_sel_hi:[1,0]
    v_pk_add_f32 v[236:237], v[236:237], 1.0 op_sel_hi:[1,0]
    v_pk_fma_f32 v[230:231], v[230:231], v[230:231], 1.0 op_sel_hi:[1,1,0]
    v_pk_fma_f32 v[232:233], v[232:233], v[232:233], 1.0 op_sel_hi:[1,1,0]
    v_pk_fma_f32 v[234:235], v[234:235], v[234:235], 1.0 op_sel_hi:[1,1,0]
    v_pk_fma_f32 v[236:237], v[236:237], v[236:237], 1.0 op_sel_hi:[1,1,0]
    v_rcp_f32 v230, v230
    v_rcp_f32 v231, v231
    v_rcp_f32 v232, v232
    v_rcp_f32 v233, v233
    v_rcp_f32 v234, v234
    v_rcp_f32 v235, v235
    v_rcp_f32 v236, v236
    v_rcp_f32 v237, v237
    v_pk_fma_f32 v[230:231], v[230:231], v[184:185], v[184:185] op_sel:[0,0,1] op_sel_hi:[1,0,1]
    v_pk_fma_f32 v[232:233], v[232:233], v[184:185], v[184:185] op_sel:[0,0,1] op_sel_hi:[1,0,1]
    v_pk_fma_f32 v[234:235], v[234:235], v[184:185], v[184:185] op_sel:[0,0,1] op_sel_hi:[1,0,1]
    v_pk_fma_f32 v[236:237], v[236:237], v[184:185], v[184:185] op_sel:[0,0,1] op_sel_hi:[1,0,1]
    v_pk_mul_f32 v[222:223], v[222:223], v[230:231]
    v_pk_mul_f32 v[224:225], v[224:225], v[232:233]
    v_pk_mul_f32 v[226:227], v[226:227], v[234:235]
    v_pk_mul_f32 v[228:229], v[228:229], v[236:237]
    v_cvt_pk_bf16_f32 v238, v222, v223
    v_cvt_pk_bf16_f32 v239, v224, v225
    v_cvt_pk_bf16_f32 v240, v226, v227
    v_cvt_pk_bf16_f32 v241, v228, v229
    buffer_store_dwordx4 v[238:241], v2, s[32:35], s58 offen sc1
    v_pk_mul_f32 v[222:223], v[120:121], v[182:183] op_sel:[0,1] op_sel_hi:[1,1]
    v_pk_mul_f32 v[224:225], v[122:123], v[182:183] op_sel:[0,1] op_sel_hi:[1,1]
    v_pk_mul_f32 v[226:227], v[124:125], v[182:183] op_sel:[0,1] op_sel_hi:[1,1]
    v_pk_mul_f32 v[228:229], v[126:127], v[182:183] op_sel:[0,1] op_sel_hi:[1,1]
    v_exp_f32 v230, v222
    v_exp_f32 v231, v223
    v_exp_f32 v232, v224
    v_exp_f32 v233, v225
    v_exp_f32 v234, v226
    v_exp_f32 v235, v227
    v_exp_f32 v236, v228
    v_exp_f32 v237, v229
    v_pk_add_f32 v[230:231], v[230:231], 1.0 op_sel_hi:[1,0]
    v_pk_add_f32 v[232:233], v[232:233], 1.0 op_sel_hi:[1,0]
    v_pk_add_f32 v[234:235], v[234:235], 1.0 op_sel_hi:[1,0]
    v_pk_add_f32 v[236:237], v[236:237], 1.0 op_sel_hi:[1,0]
    v_pk_fma_f32 v[230:231], v[230:231], v[230:231], 1.0 op_sel_hi:[1,1,0]
    v_pk_fma_f32 v[232:233], v[232:233], v[232:233], 1.0 op_sel_hi:[1,1,0]
    v_pk_fma_f32 v[234:235], v[234:235], v[234:235], 1.0 op_sel_hi:[1,1,0]
    v_pk_fma_f32 v[236:237], v[236:237], v[236:237], 1.0 op_sel_hi:[1,1,0]
    v_rcp_f32 v230, v230
    v_rcp_f32 v231, v231
    v_rcp_f32 v232, v232
    v_rcp_f32 v233, v233
    v_rcp_f32 v234, v234
    v_rcp_f32 v235, v235
    v_rcp_f32 v236, v236
    v_rcp_f32 v237, v237
    v_pk_fma_f32 v[230:231], v[230:231], v[184:185], v[184:185] op_sel:[0,0,1] op_sel_hi:[1,0,1]
    v_pk_fma_f32 v[232:233], v[232:233], v[184:185], v[184:185] op_sel:[0,0,1] op_sel_hi:[1,0,1]
    v_pk_fma_f32 v[234:235], v[234:235], v[184:185], v[184:185] op_sel:[0,0,1] op_sel_hi:[1,0,1]
    v_pk_fma_f32 v[236:237], v[236:237], v[184:185], v[184:185] op_sel:[0,0,1] op_sel_hi:[1,0,1]
    v_pk_mul_f32 v[222:223], v[222:223], v[230:231]
    v_pk_mul_f32 v[224:225], v[224:225], v[232:233]
    v_pk_mul_f32 v[226:227], v[226:227], v[234:235]
    v_pk_mul_f32 v[228:229], v[228:229], v[236:237]
    v_cvt_pk_bf16_f32 v242, v222, v223
    v_cvt_pk_bf16_f32 v243, v224, v225
    v_cvt_pk_bf16_f32 v244, v226, v227
    v_cvt_pk_bf16_f32 v245, v228, v229
    buffer_store_dwordx4 v[242:245], v2, s[32:35], s58 offen offset:1024 sc1
    s_waitcnt vmcnt(30)
    s_barrier
    ds_read_b64_tr_b16 v[48:49], v30 offset:8192
    ds_read_b64_tr_b16 v[50:51], v30 offset:8704
    ds_read_b64_tr_b16 v[52:53], v31 offset:8192
    ds_read_b64_tr_b16 v[54:55], v31 offset:8704
    s_waitcnt lgkmcnt(2)
    v_mfma_f32_32x32x16_bf16 v[128:143], v[48:51], a[0:3], 0
    ds_read_b64_tr_b16 v[56:57], v30 offset:12288
    ds_read_b64_tr_b16 v[58:59], v30 offset:12800
    v_lshrrev_b32 v20, 5, v1
    s_lshl_b32 s55, s42, 7
    v_mfma_f32_32x32x16_bf16 v[144:159], v[48:51], a[4:7], 0
    s_add_u32 s68, s55, 45056
    s_add_u32 s69, s55, 40960
    s_add_u32 s70, s55, 49152
    v_mfma_f32_16x16x32_bf16 v[44:47], v[32:35], v[48:51], 0
    s_waitcnt lgkmcnt(2)
    v_mfma_f32_32x32x16_bf16 v[128:143], v[52:55], a[8:11], v[128:143]
    ds_read_b64_tr_b16 v[60:61], v31 offset:12288
    ds_read_b64_tr_b16 v[62:63], v31 offset:12800
    ds_read_b64_tr_b16 a[0:1], v10 offset:0
    v_mfma_f32_32x32x16_bf16 v[144:159], v[52:55], a[12:15], v[144:159]
    ds_read_b64_tr_b16 a[2:3], v10 offset:1024
    ds_read_b64_tr_b16 a[4:5], v11 offset:0
    ds_read_b64_tr_b16 a[6:7], v11 offset:1024
    s_waitcnt lgkmcnt(4)
    s_waitcnt vmcnt(26)
    s_barrier
    v_mfma_f32_32x32x16_bf16 v[128:143], v[56:59], a[16:19], v[128:143]
    ds_read_b64_tr_b16 v[48:49], v30 offset:16384
    ds_read_b64_tr_b16 v[50:51], v30 offset:16896
    ds_read_b64_tr_b16 a[8:9], v10 offset:4096
    v_mfma_f32_32x32x16_bf16 v[144:159], v[56:59], a[20:23], v[144:159]
    s_add_u32 m0, s52, 106496
    s_mov_b32 s54, 1048576
    buffer_load_dwordx4 v6, s[20:23], s54 offen lds
    s_add_u32 m0, s52, 110592
    s_mov_b32 s54, 1081344
    ds_read_b64_tr_b16 a[10:11], v10 offset:5120
    ds_read_b64_tr_b16 a[12:13], v11 offset:4096
    ds_read_b64_tr_b16 a[14:15], v11 offset:5120
    v_mfma_f32_16x16x32_bf16 v[44:47], v[32:35], v[56:59], v[44:47]
    s_lshl_b32 s55, s42, 1
    v_mfma_f32_32x32x16_bf16 v[128:143], v[60:63], a[24:27], v[128:143]
    ds_read_b64_tr_b16 v[52:53], v31 offset:16384
    ds_read_b64_tr_b16 v[54:55], v31 offset:16896
    ds_read_b64_tr_b16 a[16:17], v10 offset:8192
    v_mfma_f32_32x32x16_bf16 v[144:159], v[60:63], a[28:31], v[144:159]
    buffer_load_dwordx4 v6, s[20:23], s54 offen lds
    ds_read_b64_tr_b16 a[18:19], v10 offset:9216
    ds_read_b64_tr_b16 a[20:21], v11 offset:8192
    ds_read_b64_tr_b16 a[22:23], v11 offset:9216
    s_waitcnt lgkmcnt(10)
    v_mfma_f32_32x32x16_bf16 v[128:143], v[48:51], a[32:35], v[128:143]
    ds_read_b64_tr_b16 v[56:57], v30 offset:20480
    ds_read_b64_tr_b16 v[58:59], v30 offset:20992
    ds_read_b64_tr_b16 a[24:25], v10 offset:12288
    v_mfma_f32_32x32x16_bf16 v[144:159], v[48:51], a[36:39], v[144:159]
    ds_read_b64_tr_b16 a[26:27], v10 offset:13312
    ds_read_b64_tr_b16 a[28:29], v11 offset:12288
    ds_read_b64_tr_b16 a[30:31], v11 offset:13312
    v_mfma_f32_16x16x32_bf16 v[44:47], v[32:35], v[48:51], v[44:47]
    s_waitcnt lgkmcnt(10)
    v_mfma_f32_32x32x16_bf16 v[128:143], v[52:55], a[40:43], v[128:143]
    ds_read_b64_tr_b16 v[60:61], v31 offset:20480
    ds_read_b64_tr_b16 v[62:63], v31 offset:20992
    ds_read_b64_tr_b16 a[32:33], v10 offset:16384
    v_mfma_f32_32x32x16_bf16 v[144:159], v[52:55], a[44:47], v[144:159]
    ds_read_b64_tr_b16 a[34:35], v10 offset:17408
    ds_read_b64_tr_b16 a[36:37], v11 offset:16384
    ds_read_b64_tr_b16 a[38:39], v11 offset:17408
    s_waitcnt lgkmcnt(4)
    s_waitcnt vmcnt(24)
    s_barrier
    v_mfma_f32_32x32x16_bf16 v[128:143], v[56:59], a[48:51], v[128:143]
    ds_read_b64_tr_b16 v[48:49], v30 offset:24576
    ds_read_b64_tr_b16 v[50:51], v30 offset:25088
    ds_read_b64_tr_b16 a[40:41], v10 offset:20480
    v_mfma_f32_32x32x16_bf16 v[144:159], v[56:59], a[52:55], v[144:159]
    s_add_u32 m0, s52, 114688
    s_mov_b32 s54, 1179648
    buffer_load_dwordx4 v6, s[20:23], s54 offen lds
    s_add_u32 m0, s52, 118784
    s_mov_b32 s54, 1212416
    ds_read_b64_tr_b16 a[42:43], v10 offset:21504
    ds_read_b64_tr_b16 a[44:45], v11 offset:20480
    ds_read_b64_tr_b16 a[46:47], v11 offset:21504
    v_mfma_f32_16x16x32_bf16 v[44:47], v[32:35], v[56:59], v[44:47]
    s_add_u32 s55, s55, s39
    v_mfma_f32_32x32x16_bf16 v[128:143], v[60:63], a[56:59], v[128:143]
    ds_read_b64_tr_b16 v[52:53], v31 offset:24576
    ds_read_b64_tr_b16 v[54:55], v31 offset:25088
    ds_read_b64_tr_b16 a[48:49], v8 offset:0
    v_mfma_f32_32x32x16_bf16 v[144:159], v[60:63], a[60:63], v[144:159]
    buffer_load_dwordx4 v6, s[20:23], s54 offen lds
    s_add_u32 m0, s52, 73728
    s_mov_b32 s54, 1245184
    ds_read_b64_tr_b16 a[50:51], v8 offset:1024
    ds_read_b64_tr_b16 a[52:53], v9 offset:0
    ds_read_b64_tr_b16 a[54:55], v9 offset:1024
    s_waitcnt lgkmcnt(10)
    v_mfma_f32_32x32x16_bf16 v[128:143], v[48:51], a[64:67], v[128:143]
    ds_read_b64_tr_b16 v[56:57], v30 offset:28672
    ds_read_b64_tr_b16 v[58:59], v30 offset:29184
    ds_read_b64_tr_b16 a[56:57], v8 offset:4096
    v_mfma_f32_32x32x16_bf16 v[144:159], v[48:51], a[68:71], v[144:159]
    buffer_load_dwordx4 v6, s[20:23], s54 offen lds
    s_add_u32 m0, s52, 77824
    s_mov_b32 s54, 1277952
    ds_read_b64_tr_b16 a[58:59], v8 offset:5120
    ds_read_b64_tr_b16 a[60:61], v9 offset:4096
    ds_read_b64_tr_b16 a[62:63], v9 offset:5120
    v_mfma_f32_16x16x32_bf16 v[44:47], v[32:35], v[48:51], v[44:47]
    buffer_load_dwordx4 v6, s[20:23], s54 offen lds
    s_add_u32 m0, s52, 81920
    s_mov_b32 s54, 1376256
    s_waitcnt lgkmcnt(10)
    v_mfma_f32_32x32x16_bf16 v[128:143], v[52:55], a[72:75], v[128:143]
    ds_read_b64_tr_b16 v[60:61], v31 offset:28672
    ds_read_b64_tr_b16 v[62:63], v31 offset:29184
    ds_read_b64_tr_b16 a[64:65], v8 offset:8192
    v_mfma_f32_32x32x16_bf16 v[144:159], v[52:55], a[76:79], v[144:159]
    s_waitcnt vmcnt(6)
    buffer_store_dword v7, v5, s[24:27], s65 offen
    buffer_store_dword v7, v5, s[32:35], s65 offen sc1
    ds_read_b64_tr_b16 a[66:67], v8 offset:9216
    ds_read_b64_tr_b16 a[68:69], v9 offset:8192
    ds_read_b64_tr_b16 a[70:71], v9 offset:9216
    s_waitcnt lgkmcnt(4)
    s_barrier
    v_mfma_f32_32x32x16_bf16 v[128:143], v[56:59], a[80:83], v[128:143]
    ds_read_b64_tr_b16 v[48:49], v30 offset:32768
    ds_read_b64_tr_b16 v[50:51], v30 offset:33280
    ds_read_b64_tr_b16 a[72:73], v8 offset:12288
    v_mfma_f32_32x32x16_bf16 v[144:159], v[56:59], a[84:87], v[144:159]
    buffer_load_dwordx4 v6, s[20:23], s54 offen lds
    s_add_u32 m0, s52, 86016
    s_mov_b32 s54, 131072
    ds_read_b64_tr_b16 a[74:75], v8 offset:13312
    ds_read_b64_tr_b16 a[76:77], v9 offset:12288
    ds_read_b64_tr_b16 a[78:79], v9 offset:13312
    v_mfma_f32_16x16x32_bf16 v[44:47], v[32:35], v[56:59], v[44:47]
    s_lshl_b32 s56, s55, 7
    v_mfma_f32_32x32x16_bf16 v[128:143], v[60:63], a[88:91], v[128:143]
    ds_read_b64_tr_b16 v[52:53], v31 offset:32768
    ds_read_b64_tr_b16 v[54:55], v31 offset:33280
    ds_read_b64_tr_b16 a[80:81], v8 offset:16384
    v_mfma_f32_32x32x16_bf16 v[144:159], v[60:63], a[92:95], v[144:159]
    buffer_load_dwordx4 v6, s[20:23], s54 offen lds
    s_add_u32 m0, s52, 122880
    s_mov_b32 s54, 163840
    ds_read_b64_tr_b16 a[82:83], v8 offset:17408
    ds_read_b64_tr_b16 a[84:85], v9 offset:16384
    ds_read_b64_tr_b16 a[86:87], v9 offset:17408
    s_waitcnt lgkmcnt(10)
    v_mfma_f32_32x32x16_bf16 v[128:143], v[48:51], a[96:99], v[128:143]
    ds_read_b64_tr_b16 v[56:57], v30 offset:36864
    ds_read_b64_tr_b16 v[58:59], v30 offset:37376
    ds_read_b64_tr_b16 a[88:89], v8 offset:20480
    v_mfma_f32_32x32x16_bf16 v[144:159], v[48:51], a[100:103], v[144:159]
    buffer_load_dwordx4 v6, s[20:23], s54 offen lds
    s_add_u32 m0, s52, 126976
    s_mov_b32 s54, 327680
    ds_read_b64_tr_b16 a[90:91], v8 offset:21504
    ds_read_b64_tr_b16 a[92:93], v9 offset:20480
    ds_read_b64_tr_b16 a[94:95], v9 offset:21504
    v_mfma_f32_16x16x32_bf16 v[44:47], v[32:35], v[48:51], v[44:47]
    buffer_load_dwordx4 v6, s[20:23], s54 offen lds
    s_add_u32 m0, s52, 90112
    s_mov_b32 s54, 360448
    s_waitcnt lgkmcnt(10)
    v_mfma_f32_32x32x16_bf16 v[128:143], v[52:55], a[104:107], v[128:143]
    ds_read_b64_tr_b16 v[60:61], v31 offset:36864
    ds_read_b64_tr_b16 v[62:63], v31 offset:37376
    ds_read_b64_tr_b16 a[96:97], v8 offset:24576
    v_mfma_f32_32x32x16_bf16 v[144:159], v[52:55], a[108:111], v[144:159]
    buffer_load_dwordx4 v6, s[20:23], s54 offen lds
    s_add_u32 m0, s52, 94208
    s_mov_b32 s54, 524288
    ds_read_b64_tr_b16 a[98:99], v8 offset:25600
    ds_read_b64_tr_b16 a[100:101], v9 offset:24576
    ds_read_b64_tr_b16 a[102:103], v9 offset:25600
    s_waitcnt lgkmcnt(4)
    s_barrier
    v_mfma_f32_32x32x16_bf16 v[128:143], v[56:59], a[112:115], v[128:143]
    ds_read_b64_tr_b16 v[48:49], v30 offset:40960
    ds_read_b64_tr_b16 v[50:51], v30 offset:41472
    ds_read_b64_tr_b16 a[104:105], v8 offset:28672
    v_mfma_f32_32x32x16_bf16 v[144:159], v[56:59], a[116:119], v[144:159]
    buffer_load_dwordx4 v6, s[20:23], s54 offen lds
    s_add_u32 m0, s52, 8192
    s_mov_b32 s54, 557056
    ds_read_b64_tr_b16 a[106:107], v8 offset:29696
    ds_read_b64_tr_b16 a[108:109], v9 offset:28672
    ds_read_b64_tr_b16 a[110:111], v9 offset:29696
    v_mfma_f32_16x16x32_bf16 v[44:47], v[32:35], v[56:59], v[44:47]
    s_add_u32 s56, s56, s40
    v_mfma_f32_32x32x16_bf16 v[128:143], v[60:63], a[120:123], v[128:143]
    ds_read_b64_tr_b16 v[52:53], v31 offset:40960
    ds_read_b64_tr_b16 v[54:55], v31 offset:41472
    ds_read_b64_tr_b16 a[112:113], v8 offset:32768
    v_mfma_f32_32x32x16_bf16 v[144:159], v[60:63], a[124:127], v[144:159]
    buffer_load_dwordx4 v6, s[20:23], s54 offen lds
    s_add_u32 m0, s52, 12288
    s_mov_b32 s54, 720896
    ds_read_b64_tr_b16 a[114:115], v8 offset:33792
    ds_read_b64_tr_b16 a[116:117], v9 offset:32768
    ds_read_b64_tr_b16 a[118:119], v9 offset:33792
    s_waitcnt lgkmcnt(10)
    v_mfma_f32_32x32x16_bf16 v[128:143], v[48:51], a[128:131], v[128:143]
    ds_read_b64_tr_b16 v[56:57], v30 offset:45056
    ds_read_b64_tr_b16 v[58:59], v30 offset:45568
    ds_read_b64_tr_b16 a[120:121], v8 offset:36864
    v_mfma_f32_32x32x16_bf16 v[144:159], v[48:51], a[132:135], v[144:159]
    buffer_load_dwordx4 v6, s[20:23], s54 offen lds
    s_add_u32 m0, s52, 131072
    s_mov_b32 s54, 753664
    ds_read_b64_tr_b16 a[122:123], v8 offset:37888
    ds_read_b64_tr_b16 a[124:125], v9 offset:36864
    ds_read_b64_tr_b16 a[126:127], v9 offset:37888
    v_mfma_f32_16x16x32_bf16 v[44:47], v[32:35], v[48:51], v[44:47]
    buffer_load_dwordx4 v6, s[20:23], s54 offen lds
    s_add_u32 m0, s52, 135168
    s_mov_b32 s54, 917504
    s_waitcnt lgkmcnt(10)
    v_mfma_f32_32x32x16_bf16 v[128:143], v[52:55], a[136:139], v[128:143]
    ds_read_b64_tr_b16 v[60:61], v31 offset:45056
    ds_read_b64_tr_b16 v[62:63], v31 offset:45568
    ds_read_b64_tr_b16 a[128:129], v8 offset:40960
    v_mfma_f32_32x32x16_bf16 v[144:159], v[52:55], a[140:143], v[144:159]
    buffer_load_dwordx4 v6, s[20:23], s54 offen lds
    s_add_u32 m0, s52, 16384
    s_mov_b32 s54, 950272
    ds_read_b64_tr_b16 a[130:131], v8 offset:41984
    ds_read_b64_tr_b16 a[132:133], v9 offset:40960
    ds_read_b64_tr_b16 a[134:135], v9 offset:41984
    s_waitcnt lgkmcnt(4)
    s_barrier
    v_mfma_f32_32x32x16_bf16 v[128:143], v[56:59], a[144:147], v[128:143]
    ds_read_b64_tr_b16 v[48:49], v30 offset:49152
    ds_read_b64_tr_b16 v[50:51], v30 offset:49664
    ds_read_b64_tr_b16 a[136:137], v8 offset:45056
    v_mfma_f32_32x32x16_bf16 v[144:159], v[56:59], a[148:151], v[144:159]
    buffer_load_dwordx4 v6, s[20:23], s54 offen lds
    s_add_u32 m0, s52, 20480
    s_mov_b32 s54, 1114112
    ds_read_b64_tr_b16 a[138:139], v8 offset:46080
    ds_read_b64_tr_b16 a[140:141], v9 offset:45056
    ds_read_b64_tr_b16 a[142:143], v9 offset:46080
    v_mfma_f32_16x16x32_bf16 v[44:47], v[32:35], v[56:59], v[44:47]
    s_lshl_b32 s56, s56, 10
    v_mfma_f32_32x32x16_bf16 v[128:143], v[60:63], a[152:155], v[128:143]
    ds_read_b64_tr_b16 v[52:53], v31 offset:49152
    ds_read_b64_tr_b16 v[54:55], v31 offset:49664
    ds_read_b64_tr_b16 a[144:145], v8 offset:49152
    v_mfma_f32_32x32x16_bf16 v[144:159], v[60:63], a[156:159], v[144:159]
    buffer_load_dwordx4 v6, s[20:23], s54 offen lds
    s_add_u32 m0, s52, 24576
    s_mov_b32 s54, 1146880
    ds_read_b64_tr_b16 a[146:147], v8 offset:50176
    ds_read_b64_tr_b16 a[148:149], v9 offset:49152
    ds_read_b64_tr_b16 a[150:151], v9 offset:50176
    s_waitcnt lgkmcnt(10)
    v_mfma_f32_32x32x16_bf16 v[128:143], v[48:51], a[160:163], v[128:143]
    ds_read_b64_tr_b16 v[56:57], v30 offset:53248
    ds_read_b64_tr_b16 v[58:59], v30 offset:53760
    ds_read_b64_tr_b16 a[152:153], v8 offset:53248
    v_mfma_f32_32x32x16_bf16 v[144:159], v[48:51], a[164:167], v[144:159]
    buffer_load_dwordx4 v6, s[20:23], s54 offen lds
    s_add_u32 m0, s52, 28672
    s_mov_b32 s54, 1310720
    ds_read_b64_tr_b16 a[154:155], v8 offset:54272
    ds_read_b64_tr_b16 a[156:157], v9 offset:53248
    ds_read_b64_tr_b16 a[158:159], v9 offset:54272
    v_mfma_f32_16x16x32_bf16 v[44:47], v[32:35], v[48:51], v[44:47]
    buffer_load_dwordx4 v6, s[20:23], s54 offen lds
    s_add_u32 m0, s52, 139264
    s_mov_b32 s54, 1343488
    s_waitcnt lgkmcnt(10)
    v_mfma_f32_32x32x16_bf16 v[128:143], v[52:55], a[168:171], v[128:143]
    ds_read_b64_tr_b16 v[60:61], v31 offset:53248
    ds_read_b64_tr_b16 v[62:63], v31 offset:53760
    ds_read_b64_tr_b16 a[160:161], v8 offset:57344
    v_mfma_f32_32x32x16_bf16 v[144:159], v[52:55], a[172:175], v[144:159]
    buffer_load_dwordx4 v6, s[20:23], s54 offen lds
    s_add_u32 m0, s52, 143360
    s_mov_b32 s54, 0
    ds_read_b64_tr_b16 a[162:163], v8 offset:58368
    ds_read_b64_tr_b16 a[164:165], v9 offset:57344
    ds_read_b64_tr_b16 a[166:167], v9 offset:58368
    s_waitcnt lgkmcnt(4)
    s_barrier
    v_mfma_f32_32x32x16_bf16 v[128:143], v[56:59], a[176:179], v[128:143]
    ds_read_b64_tr_b16 v[48:49], v30 offset:57344
    ds_read_b64_tr_b16 v[50:51], v30 offset:57856
    s_add_u32 s72, s56, 1048576
    s_lshl1_add_u32 s55, s55, s40
    v_mfma_f32_32x32x16_bf16 v[144:159], v[56:59], a[180:183], v[144:159]
    buffer_load_dwordx4 v6, s[16:19], s54 offen lds
    s_add_u32 m0, s52, 32768
    s_mov_b32 s54, 32768
    s_lshl_b32 s55, s55, 14
    s_lshl_b32 s56, s43, 7
    s_add_u32 s55, s55, s56
    v_mfma_f32_16x16x32_bf16 v[44:47], v[32:35], v[56:59], v[44:47]
    v_lshrrev_b32 v21, 3, v1
    v_mfma_f32_32x32x16_bf16 v[128:143], v[60:63], a[184:187], v[128:143]
    ds_read_b64_tr_b16 v[52:53], v31 offset:57344
    ds_read_b64_tr_b16 v[54:55], v31 offset:57856
    v_and_b32 v22, 7, v1
    v_lshl_add_u32 v0, v22, 4, s55
    v_mfma_f32_32x32x16_bf16 v[144:159], v[60:63], a[188:191], v[144:159]
    buffer_load_dwordx4 v6, s[16:19], s54 offen lds
    s_add_u32 m0, s52, 36864
    s_mov_b32 s54, 65536
    v_lshl_add_u32 v0, v21, 10, v0
    s_movk_i32 s90, 8192
    s_mov_b32 s30, 2097152
    s_waitcnt lgkmcnt(2)
    v_mfma_f32_32x32x16_bf16 v[128:143], v[48:51], a[192:195], v[128:143]
    ds_read_b64_tr_b16 v[56:57], v30 offset:61440
    ds_read_b64_tr_b16 v[58:59], v30 offset:61952
    s_mov_b32 s31, 0x20000
    v_and_b32 v14, 60, v167
    v_mfma_f32_32x32x16_bf16 v[144:159], v[48:51], a[196:199], v[144:159]
    buffer_load_dwordx4 v6, s[16:19], s54 offen lds
    s_add_u32 m0, s52, 40960
    s_mov_b32 s54, 98304
    v_bfe_u32 v23, v167, 2, 3
    v_xor_b32 v23, v23, v20
    s_lshl_b32 s55, s3, 13
    v_mfma_f32_16x16x32_bf16 v[44:47], v[32:35], v[48:51], v[44:47]
    buffer_load_dwordx4 v6, s[16:19], s54 offen lds
    s_add_u32 m0, s52, 45056
    s_mov_b32 s54, 131072
    s_waitcnt lgkmcnt(2)
    v_mfma_f32_32x32x16_bf16 v[128:143], v[52:55], a[200:203], v[128:143]
    ds_read_b64_tr_b16 v[60:61], v31 offset:61440
    ds_read_b64_tr_b16 v[62:63], v31 offset:61952
    s_lshl_b32 s56, s40, 7
    s_add_u32 s55, s55, s56
    v_mfma_f32_32x32x16_bf16 v[144:159], v[52:55], a[204:207], v[144:159]
    buffer_load_dwordx4 v6, s[16:19], s54 offen lds
    s_add_u32 m0, s52, 147456
    s_mov_b32 s54, 163840
    s_add_u32 s55, s55, 106496
    v_lshl_add_u32 v23, v23, 4, s55
    v_lshl_add_u32 v19, v167, 6, v23
    s_waitcnt lgkmcnt(0)
    s_barrier
    v_mfma_f32_32x32x16_bf16 v[128:143], v[56:59], a[208:211], v[128:143]
    ds_read_b64_tr_b16 v[48:49], v30 offset:0
    ds_read_b64_tr_b16 v[50:51], v30 offset:512
    v_lshlrev_b32 v22, 1, v22
    v_xor_b32 v22, v22, v21
    v_mfma_f32_32x32x16_bf16 v[144:159], v[56:59], a[212:215], v[144:159]
    buffer_load_dwordx4 v6, s[16:19], s54 offen lds
    s_add_u32 m0, s52, 151552
    s_mov_b32 s54, 196608
    s_lshl_b32 s55, s39, 13
    s_lshl_b32 s56, s40, 12
    s_add_u32 s55, s55, s56
    v_mfma_f32_16x16x32_bf16 v[44:47], v[32:35], v[56:59], v[44:47]
    s_add_u32 s55, s55, 106496
    v_mfma_f32_32x32x16_bf16 v[128:143], v[60:63], a[216:219], v[128:143]
    ds_read_b64_tr_b16 v[52:53], v31 offset:0
    ds_read_b64_tr_b16 v[54:55], v31 offset:512
    v_lshl_add_u32 v22, v22, 4, s55
    v_lshl_add_u32 v20, v21, 8, v22
    v_mfma_f32_32x32x16_bf16 v[144:159], v[60:63], a[220:223], v[144:159]
    buffer_load_dwordx4 v6, s[16:19], s54 offen lds
    s_add_u32 m0, s52, 49152
    s_mov_b32 s54, 229376
    s_waitcnt lgkmcnt(2)
    v_mfma_f32_32x32x16_bf16 v[128:143], v[48:51], a[224:227], v[128:143]
    ds_read_b64_tr_b16 v[56:57], v30 offset:4096
    ds_read_b64_tr_b16 v[58:59], v30 offset:4608
    v_mfma_f32_32x32x16_bf16 v[144:159], v[48:51], a[228:231], v[144:159]
    buffer_load_dwordx4 v6, s[16:19], s54 offen lds
    s_add_u32 m0, s52, 53248
    s_mov_b32 s54, 262144
    v_mfma_f32_16x16x32_bf16 v[44:47], v[32:35], v[48:51], v[44:47]
    buffer_load_dwordx4 v6, s[16:19], s54 offen lds
    s_add_u32 m0, s52, 57344
    s_mov_b32 s54, 294912
    s_waitcnt lgkmcnt(2)
    v_mfma_f32_32x32x16_bf16 v[128:143], v[52:55], a[232:235], v[128:143]
    ds_read_b64_tr_b16 v[60:61], v31 offset:4096
    ds_read_b64_tr_b16 v[62:63], v31 offset:4608
    v_mfma_f32_32x32x16_bf16 v[144:159], v[52:55], a[236:239], v[144:159]
    buffer_load_dwordx4 v6, s[16:19], s54 offen lds
    s_add_u32 m0, s52, 61440
    s_mov_b32 s54, 327680
    s_waitcnt lgkmcnt(2)
    v_mfma_f32_16x16x32_bf16 v[44:47], v[32:35], v[56:59], v[44:47]
    v_mfma_f32_32x32x16_bf16 v[128:143], v[56:59], a[240:243], v[128:143]
    s_nop 6
    ds_write_b32 v254, v44 offset:1024
    v_mfma_f32_32x32x16_bf16 v[144:159], v[56:59], a[244:247], v[144:159]
    buffer_load_dwordx4 v6, s[16:19], s54 offen lds
    s_add_u32 m0, s52, 155648
    s_mov_b32 s54, 360448
    s_waitcnt lgkmcnt(0)
    s_barrier
    v_mfma_f32_32x32x16_bf16 v[128:143], v[60:63], a[248:251], v[128:143]
    ds_read_b32 v45, v255 offset:1024
    buffer_load_dwordx4 v6, s[16:19], s54 offen lds
    s_add_u32 m0, s52, 159744
    s_mov_b32 s54, 393216
    v_mfma_f32_32x32x16_bf16 v[144:159], v[60:63], a[252:255], v[144:159]
    s_waitcnt lgkmcnt(0)
    v_add_f32 v44, v44, v45
    v_cvt_pk_bf16_f32 v45, v44, v44
    v_and_b32 v45, 0xffff0000, v45
    v_sub_f32 v46, v44, v45
    v_cvt_pk_bf16_f32 v160, v45, v46
    s_nop 1
    v_mfma_f32_32x32x16_bf16 v[128:143], v[160:163], v[168:171], v[128:143]
    v_mfma_f32_32x32x16_bf16 v[144:159], v[160:163], v[172:175], v[144:159]
    buffer_load_dword v15, v14, s[24:27], s68 offen sc1
    s_add_u32 s58, s53, s40
    s_lshl_b32 s58, s58, 11
    s_add_u32 s58, s58, s59
    s_nop 6
    v_pk_mul_f32 v[222:223], v[128:129], v[180:181] op_sel:[0,1] op_sel_hi:[1,1]
    buffer_load_dwordx4 v6, s[16:19], s54 offen lds
    s_add_u32 m0, s52, 65536
    s_mov_b32 s54, 425984
    v_pk_mul_f32 v[224:225], v[130:131], v[180:181] op_sel:[0,1] op_sel_hi:[1,1]
    v_pk_mul_f32 v[226:227], v[132:133], v[180:181] op_sel:[0,1] op_sel_hi:[1,1]
    v_pk_mul_f32 v[228:229], v[134:135], v[180:181] op_sel:[0,1] op_sel_hi:[1,1]
    v_exp_f32 v230, v222
    v_exp_f32 v231, v223
    v_exp_f32 v232, v224
    v_exp_f32 v233, v225
    v_exp_f32 v234, v226
    v_exp_f32 v235, v227
    v_exp_f32 v236, v228
    v_exp_f32 v237, v229
    buffer_load_dwordx4 v6, s[16:19], s54 offen lds
    s_add_u32 m0, s52, 98304
    s_mov_b32 s54, 458752
    v_pk_add_f32 v[230:231], v[230:231], 1.0 op_sel_hi:[1,0]
    v_pk_add_f32 v[232:233], v[232:233], 1.0 op_sel_hi:[1,0]
    v_pk_add_f32 v[234:235], v[234:235], 1.0 op_sel_hi:[1,0]
    v_pk_add_f32 v[236:237], v[236:237], 1.0 op_sel_hi:[1,0]
    v_pk_fma_f32 v[230:231], v[230:231], v[230:231], 1.0 op_sel_hi:[1,1,0]
    v_pk_fma_f32 v[232:233], v[232:233], v[232:233], 1.0 op_sel_hi:[1,1,0]
    v_pk_fma_f32 v[234:235], v[234:235], v[234:235], 1.0 op_sel_hi:[1,1,0]
    v_pk_fma_f32 v[236:237], v[236:237], v[236:237], 1.0 op_sel_hi:[1,1,0]
    v_rcp_f32 v230, v230
    v_rcp_f32 v231, v231
    v_rcp_f32 v232, v232
    v_rcp_f32 v233, v233
    v_rcp_f32 v234, v234
    buffer_load_dwordx4 v6, s[16:19], s54 offen lds
    s_add_u32 m0, s52, 102400
    s_mov_b32 s54, 491520
    v_rcp_f32 v235, v235
    v_rcp_f32 v236, v236
    v_rcp_f32 v237, v237
    v_pk_fma_f32 v[230:231], v[230:231], v[184:185], v[184:185] op_sel:[0,0,1] op_sel_hi:[1,0,1]
    v_pk_fma_f32 v[232:233], v[232:233], v[184:185], v[184:185] op_sel:[0,0,1] op_sel_hi:[1,0,1]
    v_pk_fma_f32 v[234:235], v[234:235], v[184:185], v[184:185] op_sel:[0,0,1] op_sel_hi:[1,0,1]
    v_pk_fma_f32 v[236:237], v[236:237], v[184:185], v[184:185] op_sel:[0,0,1] op_sel_hi:[1,0,1]
    v_pk_mul_f32 v[222:223], v[222:223], v[230:231]
    v_pk_mul_f32 v[224:225], v[224:225], v[232:233]
    v_pk_mul_f32 v[226:227], v[226:227], v[234:235]
    v_pk_mul_f32 v[228:229], v[228:229], v[236:237]
    v_cvt_pk_bf16_f32 v238, v222, v223
    v_cvt_pk_bf16_f32 v239, v224, v225
    v_cvt_pk_bf16_f32 v240, v226, v227
    v_cvt_pk_bf16_f32 v241, v228, v229
    buffer_load_dwordx4 v6, s[16:19], s54 offen lds
    buffer_store_dwordx4 v[238:241], v2, s[32:35], s58 offen sc1
    v_pk_mul_f32 v[222:223], v[136:137], v[180:181] op_sel:[0,1] op_sel_hi:[1,1]
    v_pk_mul_f32 v[224:225], v[138:139], v[180:181] op_sel:[0,1] op_sel_hi:[1,1]
    v_pk_mul_f32 v[226:227], v[140:141], v[180:181] op_sel:[0,1] op_sel_hi:[1,1]
    v_pk_mul_f32 v[228:229], v[142:143], v[180:181] op_sel:[0,1] op_sel_hi:[1,1]
    v_exp_f32 v230, v222
    v_exp_f32 v231, v223
    v_exp_f32 v232, v224
    v_exp_f32 v233, v225
    v_exp_f32 v234, v226
    v_exp_f32 v235, v227
    v_exp_f32 v236, v228
    v_exp_f32 v237, v229
    v_pk_add_f32 v[230:231], v[230:231], 1.0 op_sel_hi:[1,0]
    v_pk_add_f32 v[232:233], v[232:233], 1.0 op_sel_hi:[1,0]
    v_pk_add_f32 v[234:235], v[234:235], 1.0 op_sel_hi:[1,0]
    v_pk_add_f32 v[236:237], v[236:237], 1.0 op_sel_hi:[1,0]
    v_pk_fma_f32 v[230:231], v[230:231], v[230:231], 1.0 op_sel_hi:[1,1,0]
    v_pk_fma_f32 v[232:233], v[232:233], v[232:233], 1.0 op_sel_hi:[1,1,0]
    v_pk_fma_f32 v[234:235], v[234:235], v[234:235], 1.0 op_sel_hi:[1,1,0]
    v_pk_fma_f32 v[236:237], v[236:237], v[236:237], 1.0 op_sel_hi:[1,1,0]
    v_rcp_f32 v230, v230
    v_rcp_f32 v231, v231
    v_rcp_f32 v232, v232
    v_rcp_f32 v233, v233
    v_rcp_f32 v234, v234
    v_rcp_f32 v235, v235
    v_rcp_f32 v236, v236
    v_rcp_f32 v237, v237
    v_pk_fma_f32 v[230:231], v[230:231], v[184:185], v[184:185] op_sel:[0,0,1] op_sel_hi:[1,0,1]
    v_pk_fma_f32 v[232:233], v[232:233], v[184:185], v[184:185] op_sel:[0,0,1] op_sel_hi:[1,0,1]
    v_pk_fma_f32 v[234:235], v[234:235], v[184:185], v[184:185] op_sel:[0,0,1] op_sel_hi:[1,0,1]
    v_pk_fma_f32 v[236:237], v[236:237], v[184:185], v[184:185] op_sel:[0,0,1] op_sel_hi:[1,0,1]
    v_pk_mul_f32 v[222:223], v[222:223], v[230:231]
    v_pk_mul_f32 v[224:225], v[224:225], v[232:233]
    v_pk_mul_f32 v[226:227], v[226:227], v[234:235]
    v_pk_mul_f32 v[228:229], v[228:229], v[236:237]
    v_cvt_pk_bf16_f32 v242, v222, v223
    v_cvt_pk_bf16_f32 v243, v224, v225
    v_cvt_pk_bf16_f32 v244, v226, v227
    v_cvt_pk_bf16_f32 v245, v228, v229
    buffer_store_dwordx4 v[242:245], v2, s[32:35], s58 offen offset:1024 sc1
    s_waitcnt vmcnt(6)
    v_cmp_ne_u32 vcc, s41, v15
    s_cbranch_vccnz L_slow_13
L_back_14:
    s_add_u32 s58, s53, s40
    s_lshl_b32 s58, s58, 11
    s_add_u32 s58, s58, s59
    s_add_u32 s58, s58, 131072
    v_pk_mul_f32 v[222:223], v[144:145], v[182:183] op_sel:[0,1] op_sel_hi:[1,1]
    v_pk_mul_f32 v[224:225], v[146:147], v[182:183] op_sel:[0,1] op_sel_hi:[1,1]
    v_pk_mul_f32 v[226:227], v[148:149], v[182:183] op_sel:[0,1] op_sel_hi:[1,1]
    v_pk_mul_f32 v[228:229], v[150:151], v[182:183] op_sel:[0,1] op_sel_hi:[1,1]
    v_exp_f32 v230, v222
    v_exp_f32 v231, v223
    v_exp_f32 v232, v224
    v_exp_f32 v233, v225
    v_exp_f32 v234, v226
    buffer_load_dwordx4 v[246:249], v0, s[4:7], 0 offen
    v_exp_f32 v235, v227
    v_exp_f32 v236, v228
    v_exp_f32 v237, v229
    v_pk_add_f32 v[230:231], v[230:231], 1.0 op_sel_hi:[1,0]
    v_pk_add_f32 v[232:233], v[232:233], 1.0 op_sel_hi:[1,0]
    v_pk_add_f32 v[234:235], v[234:235], 1.0 op_sel_hi:[1,0]
    v_pk_add_f32 v[236:237], v[236:237], 1.0 op_sel_hi:[1,0]
    v_pk_fma_f32 v[230:231], v[230:231], v[230:231], 1.0 op_sel_hi:[1,1,0]
    v_pk_fma_f32 v[232:233], v[232:233], v[232:233], 1.0 op_sel_hi:[1,1,0]
    v_pk_fma_f32 v[234:235], v[234:235], v[234:235], 1.0 op_sel_hi:[1,1,0]
    v_pk_fma_f32 v[236:237], v[236:237], v[236:237], 1.0 op_sel_hi:[1,1,0]
    v_rcp_f32 v230, v230
    v_rcp_f32 v231, v231
    v_rcp_f32 v232, v232
    buffer_load_dwordx4 v[250:253], v0, s[4:7], s90 offen
    v_rcp_f32 v233, v233
    v_rcp_f32 v234, v234
    v_rcp_f32 v235, v235
    v_rcp_f32 v236, v236
    v_rcp_f32 v237, v237
    v_pk_fma_f32 v[230:231], v[230:231], v[184:185], v[184:185] op_sel:[0,0,1] op_sel_hi:[1,0,1]
    v_pk_fma_f32 v[232:233], v[232:233], v[184:185], v[184:185] op_sel:[0,0,1] op_sel_hi:[1,0,1]
    v_pk_fma_f32 v[234:235], v[234:235], v[184:185], v[184:185] op_sel:[0,0,1] op_sel_hi:[1,0,1]
    v_pk_fma_f32 v[236:237], v[236:237], v[184:185], v[184:185] op_sel:[0,0,1] op_sel_hi:[1,0,1]
    v_pk_mul_f32 v[222:223], v[222:223], v[230:231]
    v_pk_mul_f32 v[224:225], v[224:225], v[232:233]
    v_pk_mul_f32 v[226:227], v[226:227], v[234:235]
    v_pk_mul_f32 v[228:229], v[228:229], v[236:237]
    v_cvt_pk_bf16_f32 v238, v222, v223
    v_cvt_pk_bf16_f32 v239, v224, v225
    s_add_u32 s73, s72, 0
    buffer_load_dwordx4 a[168:171], v2, s[32:35], s73 offen sc1
    v_cvt_pk_bf16_f32 v240, v226, v227
    v_cvt_pk_bf16_f32 v241, v228, v229
    buffer_store_dwordx4 v[238:241], v2, s[32:35], s58 offen sc1
    v_pk_mul_f32 v[222:223], v[152:153], v[182:183] op_sel:[0,1] op_sel_hi:[1,1]
    v_pk_mul_f32 v[224:225], v[154:155], v[182:183] op_sel:[0,1] op_sel_hi:[1,1]
    v_pk_mul_f32 v[226:227], v[156:157], v[182:183] op_sel:[0,1] op_sel_hi:[1,1]
    v_pk_mul_f32 v[228:229], v[158:159], v[182:183] op_sel:[0,1] op_sel_hi:[1,1]
    v_exp_f32 v230, v222
    v_exp_f32 v231, v223
    v_exp_f32 v232, v224
    v_exp_f32 v233, v225
    v_exp_f32 v234, v226
    v_exp_f32 v235, v227
    v_exp_f32 v236, v228
    v_exp_f32 v237, v229
    s_add_u32 s73, s72, 2048
    buffer_load_dwordx4 a[172:175], v2, s[32:35], s73 offen sc1
    v_pk_add_f32 v[230:231], v[230:231], 1.0 op_sel_hi:[1,0]
    v_pk_add_f32 v[232:233], v[232:233], 1.0 op_sel_hi:[1,0]
    v_pk_add_f32 v[234:235], v[234:235], 1.0 op_sel_hi:[1,0]
    v_pk_add_f32 v[236:237], v[236:237], 1.0 op_sel_hi:[1,0]
    v_pk_fma_f32 v[230:231], v[230:231], v[230:231], 1.0 op_sel_hi:[1,1,0]
    v_pk_fma_f32 v[232:233], v[232:233], v[232:233], 1.0 op_sel_hi:[1,1,0]
    v_pk_fma_f32 v[234:235], v[234:235], v[234:235], 1.0 op_sel_hi:[1,1,0]
    v_pk_fma_f32 v[236:237], v[236:237], v[236:237], 1.0 op_sel_hi:[1,1,0]
    v_rcp_f32 v230, v230
    v_rcp_f32 v231, v231
    v_rcp_f32 v232, v232
    v_rcp_f32 v233, v233
    v_rcp_f32 v234, v234
    v_rcp_f32 v235, v235
    s_add_u32 s73, s72, 4096
    buffer_load_dwordx4 a[176:179], v2, s[32:35], s73 offen sc1
    v_rcp_f32 v236, v236
    v_rcp_f32 v237, v237
    v_pk_fma_f32 v[230:231], v[230:231], v[184:185], v[184:185] op_sel:[0,0,1] op_sel_hi:[1,0,1]
    v_pk_fma_f32 v[232:233], v[232:233], v[184:185], v[184:185] op_sel:[0,0,1] op_sel_hi:[1,0,1]
    v_pk_fma_f32 v[234:235], v[234:235], v[184:185], v[184:185] op_sel:[0,0,1] op_sel_hi:[1,0,1]
    v_pk_fma_f32 v[236:237], v[236:237], v[184:185], v[184:185] op_sel:[0,0,1] op_sel_hi:[1,0,1]
    v_pk_mul_f32 v[222:223], v[222:223], v[230:231]
    v_pk_mul_f32 v[224:225], v[224:225], v[232:233]
    v_pk_mul_f32 v[226:227], v[226:227], v[234:235]
    v_pk_mul_f32 v[228:229], v[228:229], v[236:237]
    v_cvt_pk_bf16_f32 v242, v222, v223
    v_cvt_pk_bf16_f32 v243, v224, v225
    v_cvt_pk_bf16_f32 v244, v226, v227
    v_cvt_pk_bf16_f32 v245, v228, v229
    buffer_store_dwordx4 v[242:245], v2, s[32:35], s58 offen offset:1024 sc1
    s_add_u32 s73, s72, 6144
    buffer_load_dwordx4 a[180:183], v2, s[32:35], s73 offen sc1
    s_add_u32 s73, s72, 12288
    buffer_load_dwordx4 a[184:187], v2, s[32:35], s73 offen sc1
    s_add_u32 s73, s72, 14336
    buffer_load_dwordx4 a[188:191], v2, s[32:35], s73 offen sc1
    s_add_u32 s73, s72, 16384
    buffer_load_dwordx4 a[192:195], v2, s[32:35], s73 offen sc1
    s_add_u32 s73, s72, 18432
    buffer_load_dwordx4 a[196:199], v2, s[32:35], s73 offen sc1
    s_add_u32 s73, s72, 24576
    buffer_load_dwordx4 a[200:203], v2, s[32:35], s73 offen sc1
    s_add_u32 s73, s72, 26624
    buffer_load_dwordx4 a[204:207], v2, s[32:35], s73 offen sc1
    s_add_u32 s73, s72, 28672
    buffer_load_dwordx4 a[208:211], v2, s[32:35], s73 offen sc1
    s_add_u32 s73, s72, 30720
    buffer_load_dwordx4 a[212:215], v2, s[32:35], s73 offen sc1
    s_add_u32 s73, s72, 36864
    s_waitcnt vmcnt(13)
    v_mfma_f32_32x32x16_bf16 v[80:95], a[4:7], a[168:171], 0
    buffer_load_dwordx4 a[216:219], v2, s[32:35], s73 offen sc1
    s_add_u32 s73, s72, 38912
    v_mfma_f32_32x32x16_bf16 v[64:79], a[0:3], a[168:171], 0
    s_waitcnt vmcnt(12)
    v_mfma_f32_32x32x16_bf16 v[80:95], a[12:15], a[172:175], v[80:95]
    buffer_load_dwordx4 a[220:223], v2, s[32:35], s73 offen sc1
    s_add_u32 s73, s72, 40960
    v_mfma_f32_32x32x16_bf16 v[64:79], a[8:11], a[172:175], v[64:79]
    s_waitcnt vmcnt(12)
    v_mfma_f32_32x32x16_bf16 v[80:95], a[20:23], a[176:179], v[80:95]
    buffer_load_dwordx4 a[224:227], v2, s[32:35], s73 offen sc1
    s_add_u32 s73, s72, 43008
    v_mfma_f32_32x32x16_bf16 v[64:79], a[16:19], a[176:179], v[64:79]
    s_waitcnt vmcnt(11)
    buffer_store_dword v7, v5, s[24:27], s75 offen
    buffer_store_dword v7, v5, s[32:35], s75 offen sc1
    v_mfma_f32_32x32x16_bf16 v[80:95], a[28:31], a[180:183], v[80:95]
    buffer_load_dwordx4 a[228:231], v2, s[32:35], s73 offen sc1
    s_add_u32 s73, s72, 49152
    v_mfma_f32_32x32x16_bf16 v[64:79], a[24:27], a[180:183], v[64:79]
    s_waitcnt vmcnt(13)
    v_mfma_f32_32x32x16_bf16 v[80:95], a[36:39], a[184:187], v[80:95]
    buffer_load_dwordx4 a[232:235], v2, s[32:35], s73 offen sc1
    s_add_u32 s73, s72, 51200
    v_mfma_f32_32x32x16_bf16 v[64:79], a[32:35], a[184:187], v[64:79]
    s_waitcnt vmcnt(13)
    v_mfma_f32_32x32x16_bf16 v[80:95], a[44:47], a[188:191], v[80:95]
    buffer_load_dwordx4 a[236:239], v2, s[32:35], s73 offen sc1
    s_add_u32 s73, s72, 53248
    v_mfma_f32_32x32x16_bf16 v[64:79], a[40:43], a[188:191], v[64:79]
    s_waitcnt vmcnt(13)
    v_mfma_f32_32x32x16_bf16 v[80:95], a[52:55], a[192:195], v[80:95]
    buffer_load_dwordx4 a[240:243], v2, s[32:35], s73 offen sc1
    s_add_u32 s73, s72, 55296
    v_mfma_f32_32x32x16_bf16 v[64:79], a[48:51], a[192:195], v[64:79]
    s_waitcnt vmcnt(13)
    v_mfma_f32_32x32x16_bf16 v[80:95], a[60:63], a[196:199], v[80:95]
    buffer_load_dwordx4 a[244:247], v2, s[32:35], s73 offen sc1
    s_add_u32 s73, s72, 61440
    v_mfma_f32_32x32x16_bf16 v[64:79], a[56:59], a[196:199], v[64:79]
    s_waitcnt vmcnt(13)
    v_mfma_f32_32x32x16_bf16 v[80:95], a[68:71], a[200:203], v[80:95]
    buffer_load_dwordx4 a[248:251], v2, s[32:35], s73 offen sc1
    s_add_u32 s73, s72, 63488
    v_lshlrev_b32 v96, 16, v246
    v_and_b32 v97, 0xffff0000, v246
    v_mfma_f32_32x32x16_bf16 v[64:79], a[64:67], a[200:203], v[64:79]
    v_lshlrev_b32 v98, 16, v247
    v_and_b32 v99, 0xffff0000, v247
    buffer_load_dword v15, v14, s[24:27], s69 offen sc1
    s_waitcnt vmcnt(14)
    v_mfma_f32_32x32x16_bf16 v[80:95], a[76:79], a[204:207], v[80:95]
    buffer_load_dwordx4 a[252:255], v2, s[32:35], s73 offen sc1
    s_add_u32 s73, s72, 65536
    v_lshlrev_b32 v100, 16, v248
    v_and_b32 v101, 0xffff0000, v248
    v_mfma_f32_32x32x16_bf16 v[64:79], a[72:75], a[204:207], v[64:79]
    v_lshlrev_b32 v102, 16, v249
    v_and_b32 v103, 0xffff0000, v249
    s_waitcnt vmcnt(14)
    v_mfma_f32_32x32x16_bf16 v[80:95], a[84:87], a[208:211], v[80:95]
    buffer_load_dwordx4 a[168:171], v2, s[32:35], s73 offen sc1
    s_add_u32 s73, s72, 67584
    v_lshlrev_b32 v104, 16, v250
    v_and_b32 v105, 0xffff0000, v250
    v_mfma_f32_32x32x16_bf16 v[64:79], a[80:83], a[208:211], v[64:79]
    v_lshlrev_b32 v106, 16, v251
    v_and_b32 v107, 0xffff0000, v251
    s_waitcnt vmcnt(14)
    v_mfma_f32_32x32x16_bf16 v[80:95], a[92:95], a[212:215], v[80:95]
    buffer_load_dwordx4 a[172:175], v2, s[32:35], s73 offen sc1
    s_add_u32 s73, s72, 73728
    v_lshlrev_b32 v108, 16, v252
    v_and_b32 v109, 0xffff0000, v252
    v_mfma_f32_32x32x16_bf16 v[64:79], a[88:91], a[212:215], v[64:79]
    v_lshlrev_b32 v110, 16, v253
    v_and_b32 v111, 0xffff0000, v253
    s_waitcnt vmcnt(14)
    v_mfma_f32_32x32x16_bf16 v[80:95], a[100:103], a[216:219], v[80:95]
    buffer_load_dwordx4 a[176:179], v2, s[32:35], s73 offen sc1
    s_add_u32 s73, s72, 75776
    v_xor_b32 v112, 0, v19
    v_xor_b32 v113, 32, v19
    v_mfma_f32_32x32x16_bf16 v[64:79], a[96:99], a[216:219], v[64:79]
    v_xor_b32 v114, 64, v19
    v_xor_b32 v115, 96, v19
    s_waitcnt vmcnt(14)
    v_mfma_f32_32x32x16_bf16 v[80:95], a[108:111], a[220:223], v[80:95]
    buffer_load_dwordx4 a[180:183], v2, s[32:35], s73 offen sc1
    s_add_u32 s73, s72, 77824
    v_xor_b32 v116, 128, v19
    v_xor_b32 v117, 160, v19
    v_mfma_f32_32x32x16_bf16 v[64:79], a[104:107], a[220:223], v[64:79]
    v_xor_b32 v118, 192, v19
    v_xor_b32 v119, 224, v19
    s_waitcnt vmcnt(14)
    v_mfma_f32_32x32x16_bf16 v[80:95], a[116:119], a[224:227], v[80:95]
    buffer_load_dwordx4 a[184:187], v2, s[32:35], s73 offen sc1
    s_add_u32 s73, s72, 79872
    v_xor_b32 v21, 16, v20
    v_mfma_f32_32x32x16_bf16 v[64:79], a[112:115], a[224:227], v[64:79]
    s_waitcnt vmcnt(12)
    v_mfma_f32_32x32x16_bf16 v[80:95], a[124:127], a[228:231], v[80:95]
    buffer_load_dwordx4 a[188:191], v2, s[32:35], s73 offen sc1
    s_add_u32 s73, s72, 86016
    v_mfma_f32_32x32x16_bf16 v[64:79], a[120:123], a[228:231], v[64:79]
    s_waitcnt vmcnt(12)
    v_mfma_f32_32x32x16_bf16 v[80:95], a[132:135], a[232:235], v[80:95]
    buffer_load_dwordx4 a[192:195], v2, s[32:35], s73 offen sc1
    s_add_u32 s73, s72, 8192
    v_mfma_f32_32x32x16_bf16 v[64:79], a[128:131], a[232:235], v[64:79]
    s_waitcnt vmcnt(8)
    v_cmp_ne_u32 vcc, s41, v15
    s_cbranch_vccnz L_slow_15
L_back_16:
    v_mfma_f32_32x32x16_bf16 v[80:95], a[140:143], a[236:239], v[80:95]
    buffer_load_dwordx4 a[196:199], v2, s[32:35], s73 offen sc1
    s_add_u32 s73, s72, 10240
    v_mfma_f32_32x32x16_bf16 v[64:79], a[136:139], a[236:239], v[64:79]
    v_mfma_f32_32x32x16_bf16 v[80:95], a[148:151], a[240:243], v[80:95]
    buffer_load_dwordx4 a[200:203], v2, s[32:35], s73 offen sc1
    s_add_u32 s73, s72, 20480
    v_mfma_f32_32x32x16_bf16 v[64:79], a[144:147], a[240:243], v[64:79]
    s_barrier
    v_mfma_f32_32x32x16_bf16 v[80:95], a[156:159], a[244:247], v[80:95]
    buffer_load_dwordx4 a[204:207], v2, s[32:35], s73 offen sc1
    s_add_u32 s73, s72, 22528
    ds_read_b64_tr_b16 v[40:41], v8 offset:61440
    ds_read_b64_tr_b16 v[42:43], v8 offset:62464
    v_mfma_f32_32x32x16_bf16 v[64:79], a[152:155], a[244:247], v[64:79]
    ds_read_b64_tr_b16 v[44:45], v9 offset:61440
    ds_read_b64_tr_b16 v[46:47], v9 offset:62464
    v_mfma_f32_32x32x16_bf16 v[80:95], a[164:167], a[248:251], v[80:95]
    buffer_load_dwordx4 a[208:211], v2, s[32:35], s73 offen sc1
    s_add_u32 s73, s72, 32768
    ds_read_b64_tr_b16 v[48:49], v10 offset:32768
    ds_read_b64_tr_b16 v[50:51], v10 offset:33792
    v_mfma_f32_32x32x16_bf16 v[64:79], a[160:163], a[248:251], v[64:79]
    ds_read_b64_tr_b16 v[52:53], v11 offset:32768
    ds_read_b64_tr_b16 v[54:55], v11 offset:33792
    s_waitcnt vmcnt(11)
    s_waitcnt lgkmcnt(4)
    v_mfma_f32_32x32x16_bf16 v[80:95], v[44:47], a[252:255], v[80:95]
    buffer_load_dwordx4 a[212:215], v2, s[32:35], s73 offen sc1
    s_add_u32 s73, s72, 34816
    ds_read_b64_tr_b16 v[56:57], v10 offset:36864
    ds_read_b64_tr_b16 v[58:59], v10 offset:37888
    v_mfma_f32_32x32x16_bf16 v[64:79], v[40:43], a[252:255], v[64:79]
    ds_read_b64_tr_b16 v[60:61], v11 offset:36864
    ds_read_b64_tr_b16 v[62:63], v11 offset:37888
    s_waitcnt vmcnt(11)
    s_waitcnt lgkmcnt(4)
    v_mfma_f32_32x32x16_bf16 v[80:95], v[52:55], a[168:171], v[80:95]
    buffer_load_dwordx4 a[216:219], v2, s[32:35], s73 offen sc1
    s_add_u32 s73, s72, 45056
    ds_read_b64_tr_b16 v[32:33], v10 offset:40960
    ds_read_b64_tr_b16 v[34:35], v10 offset:41984
    v_mfma_f32_32x32x16_bf16 v[64:79], v[48:51], a[168:171], v[64:79]
    ds_read_b64_tr_b16 v[36:37], v11 offset:40960
    ds_read_b64_tr_b16 v[38:39], v11 offset:41984
    buffer_load_dword v15, v14, s[32:35], s70 offen sc1
    s_waitcnt vmcnt(12)
    s_waitcnt lgkmcnt(4)
    v_mfma_f32_32x32x16_bf16 v[80:95], v[60:63], a[172:175], v[80:95]
    buffer_load_dwordx4 a[220:223], v2, s[32:35], s73 offen sc1
    s_add_u32 s73, s72, 47104
    ds_read_b64_tr_b16 v[40:41], v10 offset:45056
    ds_read_b64_tr_b16 v[42:43], v10 offset:46080
    v_mfma_f32_32x32x16_bf16 v[64:79], v[56:59], a[172:175], v[64:79]
    ds_read_b64_tr_b16 v[44:45], v11 offset:45056
    ds_read_b64_tr_b16 v[46:47], v11 offset:46080
    s_waitcnt vmcnt(12)
    s_waitcnt lgkmcnt(4)
    v_mfma_f32_32x32x16_bf16 v[80:95], v[36:39], a[176:179], v[80:95]
    buffer_load_dwordx4 a[224:227], v2, s[32:35], s73 offen sc1
    s_add_u32 s73, s72, 57344
    ds_read_b64_tr_b16 v[48:49], v10 offset:0
    ds_read_b64_tr_b16 v[50:51], v10 offset:1024
    v_mfma_f32_32x32x16_bf16 v[64:79], v[32:35], a[176:179], v[64:79]
    ds_read_b64_tr_b16 v[52:53], v11 offset:0
    ds_read_b64_tr_b16 v[54:55], v11 offset:1024
    s_waitcnt vmcnt(12)
    s_waitcnt lgkmcnt(4)
    v_mfma_f32_32x32x16_bf16 v[80:95], v[44:47], a[180:183], v[80:95]
    buffer_load_dwordx4 a[228:231], v2, s[32:35], s73 offen sc1
    s_add_u32 s73, s72, 59392
    ds_read_b64_tr_b16 v[56:57], v10 offset:4096
    ds_read_b64_tr_b16 v[58:59], v10 offset:5120
    v_mfma_f32_32x32x16_bf16 v[64:79], v[40:43], a[180:183], v[64:79]
    ds_read_b64_tr_b16 v[60:61], v11 offset:4096
    ds_read_b64_tr_b16 v[62:63], v11 offset:5120
    s_waitcnt vmcnt(12)
    s_waitcnt lgkmcnt(4)
    v_mfma_f32_32x32x16_bf16 v[80:95], v[52:55], a[184:187], v[80:95]
    buffer_load_dwordx4 a[232:235], v2, s[32:35], s73 offen sc1
    s_add_u32 s73, s72, 69632
    ds_read_b64_tr_b16 v[32:33], v10 offset:8192
    ds_read_b64_tr_b16 v[34:35], v10 offset:9216
    v_mfma_f32_32x32x16_bf16 v[64:79], v[48:51], a[184:187], v[64:79]
    ds_read_b64_tr_b16 v[36:37], v11 offset:8192
    ds_read_b64_tr_b16 v[38:39], v11 offset:9216
    s_waitcnt vmcnt(12)
    s_waitcnt lgkmcnt(4)
    v_mfma_f32_32x32x16_bf16 v[80:95], v[60:63], a[188:191], v[80:95]
    buffer_load_dwordx4 a[236:239], v2, s[32:35], s73 offen sc1
    s_add_u32 s73, s72, 71680
    ds_read_b64_tr_b16 v[40:41], v10 offset:12288
    ds_read_b64_tr_b16 v[42:43], v10 offset:13312
    v_mfma_f32_32x32x16_bf16 v[64:79], v[56:59], a[188:191], v[64:79]
    ds_read_b64_tr_b16 v[44:45], v11 offset:12288
    ds_read_b64_tr_b16 v[46:47], v11 offset:13312
    s_waitcnt vmcnt(12)
    s_waitcnt lgkmcnt(4)
    v_mfma_f32_32x32x16_bf16 v[80:95], v[36:39], a[192:195], v[80:95]
    buffer_load_dwordx4 a[240:243], v2, s[32:35], s73 offen sc1
    s_add_u32 s73, s72, 81920
    ds_read_b64_tr_b16 v[48:49], v10 offset:49152
    ds_read_b64_tr_b16 v[50:51], v10 offset:50176
    v_mfma_f32_32x32x16_bf16 v[64:79], v[32:35], a[192:195], v[64:79]
    ds_read_b64_tr_b16 v[52:53], v11 offset:49152
    ds_read_b64_tr_b16 v[54:55], v11 offset:50176
    s_waitcnt vmcnt(12)
    s_waitcnt lgkmcnt(4)
    v_mfma_f32_32x32x16_bf16 v[80:95], v[44:47], a[196:199], v[80:95]
    buffer_load_dwordx4 a[244:247], v2, s[32:35], s73 offen sc1
    s_add_u32 s73, s72, 83968
    ds_read_b64_tr_b16 v[56:57], v10 offset:53248
    ds_read_b64_tr_b16 v[58:59], v10 offset:54272
    v_mfma_f32_32x32x16_bf16 v[64:79], v[40:43], a[196:199], v[64:79]
    ds_read_b64_tr_b16 v[60:61], v11 offset:53248
    ds_read_b64_tr_b16 v[62:63], v11 offset:54272
    s_waitcnt vmcnt(12)
    s_waitcnt lgkmcnt(4)
    v_mfma_f32_32x32x16_bf16 v[80:95], v[52:55], a[200:203], v[80:95]
    buffer_load_dwordx4 a[248:251], v2, s[32:35], s73 offen sc1
    s_add_u32 s73, s72, 98304
    ds_read_b64_tr_b16 v[32:33], v10 offset:16384
    ds_read_b64_tr_b16 v[34:35], v10 offset:17408
    v_mfma_f32_32x32x16_bf16 v[64:79], v[48:51], a[200:203], v[64:79]
    ds_read_b64_tr_b16 v[36:37], v11 offset:16384
    ds_read_b64_tr_b16 v[38:39], v11 offset:17408
    s_waitcnt vmcnt(8)
    v_cmp_ne_u32 vcc, s41, v15
    s_cbranch_vccnz L_slow_17
L_back_18:
    s_waitcnt lgkmcnt(4)
    v_mfma_f32_32x32x16_bf16 v[80:95], v[60:63], a[204:207], v[80:95]
    buffer_load_dwordx4 a[252:255], v2, s[32:35], s73 offen sc1
    s_add_u32 s73, s72, 100352
    ds_read_b64_tr_b16 v[40:41], v10 offset:20480
    ds_read_b64_tr_b16 v[42:43], v10 offset:21504
    v_mfma_f32_32x32x16_bf16 v[64:79], v[56:59], a[204:207], v[64:79]
    ds_read_b64_tr_b16 v[44:45], v11 offset:20480
    ds_read_b64_tr_b16 v[46:47], v11 offset:21504
    s_waitcnt lgkmcnt(4)
    v_mfma_f32_32x32x16_bf16 v[80:95], v[36:39], a[208:211], v[80:95]
    buffer_load_dwordx4 a[168:171], v2, s[32:35], s73 offen sc1
    s_add_u32 s73, s72, 102400
    ds_read_b64_tr_b16 v[48:49], v8 offset:0
    ds_read_b64_tr_b16 v[50:51], v8 offset:1024
    v_mfma_f32_32x32x16_bf16 v[64:79], v[32:35], a[208:211], v[64:79]
    ds_read_b64_tr_b16 v[52:53], v9 offset:0
    ds_read_b64_tr_b16 v[54:55], v9 offset:1024
    s_waitcnt lgkmcnt(4)
    v_mfma_f32_32x32x16_bf16 v[80:95], v[44:47], a[212:215], v[80:95]
    buffer_load_dwordx4 a[172:175], v2, s[32:35], s73 offen sc1
    s_add_u32 s73, s72, 104448
    ds_read_b64_tr_b16 v[56:57], v8 offset:4096
    ds_read_b64_tr_b16 v[58:59], v8 offset:5120
    v_mfma_f32_32x32x16_bf16 v[64:79], v[40:43], a[212:215], v[64:79]
    ds_read_b64_tr_b16 v[60:61], v9 offset:4096
    ds_read_b64_tr_b16 v[62:63], v9 offset:5120
    s_waitcnt lgkmcnt(4)
    v_mfma_f32_32x32x16_bf16 v[80:95], v[52:55], a[216:219], v[80:95]
    buffer_load_dwordx4 a[176:179], v2, s[32:35], s73 offen sc1
    s_add_u32 s73, s72, 106496
    ds_read_b64_tr_b16 v[32:33], v10 offset:57344
    ds_read_b64_tr_b16 v[34:35], v10 offset:58368
    v_mfma_f32_32x32x16_bf16 v[64:79], v[48:51], a[216:219], v[64:79]
    ds_read_b64_tr_b16 v[36:37], v11 offset:57344
    ds_read_b64_tr_b16 v[38:39], v11 offset:58368
    s_waitcnt vmcnt(11)
    s_waitcnt lgkmcnt(4)
    v_mfma_f32_32x32x16_bf16 v[80:95], v[60:63], a[220:223], v[80:95]
    buffer_load_dwordx4 a[180:183], v2, s[32:35], s73 offen sc1
    s_add_u32 s73, s72, 108544
    ds_read_b64_tr_b16 v[40:41], v10 offset:61440
    ds_read_b64_tr_b16 v[42:43], v10 offset:62464
    v_mfma_f32_32x32x16_bf16 v[64:79], v[56:59], a[220:223], v[64:79]
    ds_read_b64_tr_b16 v[44:45], v11 offset:61440
    ds_read_b64_tr_b16 v[46:47], v11 offset:62464
    s_waitcnt vmcnt(11)
    s_waitcnt lgkmcnt(4)
    v_mfma_f32_32x32x16_bf16 v[80:95], v[36:39], a[224:227], v[80:95]
    buffer_load_dwordx4 a[184:187], v2, s[32:35], s73 offen sc1
    s_add_u32 s73, s72, 110592
    ds_read_b64_tr_b16 v[48:49], v8 offset:8192
    ds_read_b64_tr_b16 v[50:51], v8 offset:9216
    v_mfma_f32_32x32x16_bf16 v[64:79], v[32:35], a[224:227], v[64:79]
    ds_read_b64_tr_b16 v[52:53], v9 offset:8192
    ds_read_b64_tr_b16 v[54:55], v9 offset:9216
    s_waitcnt vmcnt(11)
    s_waitcnt lgkmcnt(4)
    v_mfma_f32_32x32x16_bf16 v[80:95], v[44:47], a[228:231], v[80:95]
    buffer_load_dwordx4 a[188:191], v2, s[32:35], s73 offen sc1
    s_add_u32 s73, s72, 112640
    ds_read_b64_tr_b16 v[56:57], v8 offset:12288
    ds_read_b64_tr_b16 v[58:59], v8 offset:13312
    v_mfma_f32_32x32x16_bf16 v[64:79], v[40:43], a[228:231], v[64:79]
    ds_read_b64_tr_b16 v[60:61], v9 offset:12288
    ds_read_b64_tr_b16 v[62:63], v9 offset:13312
    s_waitcnt vmcnt(11)
    s_waitcnt lgkmcnt(4)
    v_mfma_f32_32x32x16_bf16 v[80:95], v[52:55], a[232:235], v[80:95]
    buffer_load_dwordx4 a[192:195], v2, s[32:35], s73 offen sc1
    s_add_u32 s73, s72, 114688
    ds_read_b64_tr_b16 v[32:33], v8 offset:16384
    ds_read_b64_tr_b16 v[34:35], v8 offset:17408
    v_mfma_f32_32x32x16_bf16 v[64:79], v[48:51], a[232:235], v[64:79]
    ds_read_b64_tr_b16 v[36:37], v9 offset:16384
    ds_read_b64_tr_b16 v[38:39], v9 offset:17408
    s_waitcnt vmcnt(11)
    s_waitcnt lgkmcnt(4)
    v_mfma_f32_32x32x16_bf16 v[80:95], v[60:63], a[236:239], v[80:95]
    buffer_load_dwordx4 a[196:199], v2, s[32:35], s73 offen sc1
    s_add_u32 s73, s72, 116736
    ds_read_b64_tr_b16 v[40:41], v8 offset:20480
    ds_read_b64_tr_b16 v[42:43], v8 offset:21504
    v_mfma_f32_32x32x16_bf16 v[64:79], v[56:59], a[236:239], v[64:79]
    ds_read_b64_tr_b16 v[44:45], v9 offset:20480
    ds_read_b64_tr_b16 v[46:47], v9 offset:21504
    s_waitcnt vmcnt(11)
    s_waitcnt lgkmcnt(4)
    v_mfma_f32_32x32x16_bf16 v[80:95], v[36:39], a[240:243], v[80:95]
    buffer_load_dwordx4 a[200:203], v2, s[32:35], s73 offen sc1
    s_add_u32 s73, s72, 118784
    ds_read_b64_tr_b16 v[48:49], v12 offset:0
    ds_read_b64_tr_b16 v[50:51], v12 offset:1024
    v_mfma_f32_32x32x16_bf16 v[64:79], v[32:35], a[240:243], v[64:79]
    ds_read_b64_tr_b16 v[52:53], v13 offset:0
    ds_read_b64_tr_b16 v[54:55], v13 offset:1024
    s_waitcnt vmcnt(11)
    s_waitcnt lgkmcnt(4)
    v_mfma_f32_32x32x16_bf16 v[80:95], v[44:47], a[244:247], v[80:95]
    buffer_load_dwordx4 a[204:207], v2, s[32:35], s73 offen sc1
    s_add_u32 s73, s72, 120832
    ds_read_b64_tr_b16 v[56:57], v12 offset:4096
    ds_read_b64_tr_b16 v[58:59], v12 offset:5120
    v_mfma_f32_32x32x16_bf16 v[64:79], v[40:43], a[244:247], v[64:79]
    ds_read_b64_tr_b16 v[60:61], v13 offset:4096
    ds_read_b64_tr_b16 v[62:63], v13 offset:5120
    s_waitcnt vmcnt(11)
    s_waitcnt lgkmcnt(4)
    v_mfma_f32_32x32x16_bf16 v[80:95], v[52:55], a[248:251], v[80:95]
    buffer_load_dwordx4 a[208:211], v2, s[32:35], s73 offen sc1
    s_add_u32 s73, s72, 122880
    ds_read_b64_tr_b16 v[32:33], v8 offset:24576
    ds_read_b64_tr_b16 v[34:35], v8 offset:25600
    v_mfma_f32_32x32x16_bf16 v[64:79], v[48:51], a[248:251], v[64:79]
    ds_read_b64_tr_b16 v[36:37], v9 offset:24576
    ds_read_b64_tr_b16 v[38:39], v9 offset:25600
    s_waitcnt vmcnt(11)
    s_waitcnt lgkmcnt(4)
    v_mfma_f32_32x32x16_bf16 v[80:95], v[60:63], a[252:255], v[80:95]
    buffer_load_dwordx4 a[212:215], v2, s[32:35], s73 offen sc1
    s_add_u32 s73, s72, 124928
    ds_read_b64_tr_b16 v[40:41], v8 offset:28672
    ds_read_b64_tr_b16 v[42:43], v8 offset:29696
    v_mfma_f32_32x32x16_bf16 v[64:79], v[56:59], a[252:255], v[64:79]
    ds_read_b64_tr_b16 v[44:45], v9 offset:28672
    ds_read_b64_tr_b16 v[46:47], v9 offset:29696
    s_barrier
    s_waitcnt vmcnt(11)
    s_waitcnt lgkmcnt(4)
    v_mfma_f32_32x32x16_bf16 v[80:95], v[36:39], a[168:171], v[80:95]
    buffer_load_dwordx4 a[216:219], v2, s[32:35], s73 offen sc1
    s_add_u32 s73, s72, 126976
    ds_read_b64_tr_b16 v[48:49], v8 offset:32768
    ds_read_b64_tr_b16 v[50:51], v8 offset:33792
    v_mfma_f32_32x32x16_bf16 v[64:79], v[32:35], a[168:171], v[64:79]
    ds_read_b64_tr_b16 v[52:53], v9 offset:32768
    ds_read_b64_tr_b16 v[54:55], v9 offset:33792
    s_waitcnt vmcnt(11)
    s_waitcnt lgkmcnt(4)
    v_mfma_f32_32x32x16_bf16 v[80:95], v[44:47], a[172:175], v[80:95]
    buffer_load_dwordx4 a[220:223], v2, s[32:35], s73 offen sc1
    s_add_u32 s73, s72, 129024
    ds_read_b64_tr_b16 v[56:57], v8 offset:36864
    ds_read_b64_tr_b16 v[58:59], v8 offset:37888
    v_mfma_f32_32x32x16_bf16 v[64:79], v[40:43], a[172:175], v[64:79]
    ds_read_b64_tr_b16 v[60:61], v9 offset:36864
    ds_read_b64_tr_b16 v[62:63], v9 offset:37888
    s_waitcnt vmcnt(11)
    s_waitcnt lgkmcnt(4)
    v_mfma_f32_32x32x16_bf16 v[80:95], v[52:55], a[176:179], v[80:95]
    buffer_load_dwordx4 a[224:227], v2, s[32:35], s73 offen sc1
    ds_read_b64_tr_b16 v[32:33], v12 offset:8192
    ds_read_b64_tr_b16 v[34:35], v12 offset:9216
    v_mfma_f32_32x32x16_bf16 v[64:79], v[48:51], a[176:179], v[64:79]
    ds_read_b64_tr_b16 v[36:37], v13 offset:8192
    ds_read_b64_tr_b16 v[38:39], v13 offset:9216
    s_waitcnt vmcnt(11)
    s_waitcnt lgkmcnt(4)
    v_mfma_f32_32x32x16_bf16 v[80:95], v[60:63], a[180:183], v[80:95]
    ds_read_b64_tr_b16 v[40:41], v12 offset:12288
    ds_read_b64_tr_b16 v[42:43], v12 offset:13312
    v_mfma_f32_32x32x16_bf16 v[64:79], v[56:59], a[180:183], v[64:79]
    ds_read_b64_tr_b16 v[44:45], v13 offset:12288
    ds_read_b64_tr_b16 v[46:47], v13 offset:13312
    s_or_b32 s55, s2, s3
    s_cmp_eq_u32 s55, 0
    s_cselect_b32 s55, 0, 2147418112
    v_or_b32 v16, s55, v5
    buffer_store_dword v7, v16, s[32:35], 0 offen offset:0
    s_waitcnt vmcnt(11)
    s_waitcnt lgkmcnt(4)
    v_mfma_f32_32x32x16_bf16 v[80:95], v[36:39], a[184:187], v[80:95]
    ds_read_b64_tr_b16 v[48:49], v8 offset:40960
    ds_read_b64_tr_b16 v[50:51], v8 offset:41984
    v_mfma_f32_32x32x16_bf16 v[64:79], v[32:35], a[184:187], v[64:79]
    ds_read_b64_tr_b16 v[52:53], v9 offset:40960
    ds_read_b64_tr_b16 v[54:55], v9 offset:41984
    s_waitcnt vmcnt(10)
    s_waitcnt lgkmcnt(4)
    v_mfma_f32_32x32x16_bf16 v[80:95], v[44:47], a[188:191], v[80:95]
    ds_read_b64_tr_b16 v[56:57], v8 offset:45056
    ds_read_b64_tr_b16 v[58:59], v8 offset:46080
    v_mfma_f32_32x32x16_bf16 v[64:79], v[40:43], a[188:191], v[64:79]
    ds_read_b64_tr_b16 v[60:61], v9 offset:45056
    ds_read_b64_tr_b16 v[62:63], v9 offset:46080
    s_waitcnt vmcnt(9)
    s_waitcnt lgkmcnt(4)
    v_mfma_f32_32x32x16_bf16 v[80:95], v[52:55], a[192:195], v[80:95]
    ds_read_b64_tr_b16 v[32:33], v8 offset:49152
    ds_read_b64_tr_b16 v[34:35], v8 offset:50176
    v_mfma_f32_32x32x16_bf16 v[64:79], v[48:51], a[192:195], v[64:79]
    ds_read_b64_tr_b16 v[36:37], v9 offset:49152
    ds_read_b64_tr_b16 v[38:39], v9 offset:50176
    s_waitcnt vmcnt(8)
    s_waitcnt lgkmcnt(4)
    v_mfma_f32_32x32x16_bf16 v[80:95], v[60:63], a[196:199], v[80:95]
    ds_read_b64_tr_b16 v[40:41], v8 offset:53248
    ds_read_b64_tr_b16 v[42:43], v8 offset:54272
    v_mfma_f32_32x32x16_bf16 v[64:79], v[56:59], a[196:199], v[64:79]
    ds_read_b64_tr_b16 v[44:45], v9 offset:53248
    ds_read_b64_tr_b16 v[46:47], v9 offset:54272
    s_waitcnt vmcnt(7)
    s_waitcnt lgkmcnt(4)
    v_mfma_f32_32x32x16_bf16 v[80:95], v[36:39], a[200:203], v[80:95]
    ds_read_b64_tr_b16 v[48:49], v12 offset:16384
    ds_read_b64_tr_b16 v[50:51], v12 offset:17408
    v_mfma_f32_32x32x16_bf16 v[64:79], v[32:35], a[200:203], v[64:79]
    ds_read_b64_tr_b16 v[52:53], v13 offset:16384
    ds_read_b64_tr_b16 v[54:55], v13 offset:17408
    s_waitcnt vmcnt(6)
    s_waitcnt lgkmcnt(4)
    v_mfma_f32_32x32x16_bf16 v[80:95], v[44:47], a[204:207], v[80:95]
    ds_read_b64_tr_b16 v[56:57], v12 offset:20480
    ds_read_b64_tr_b16 v[58:59], v12 offset:21504
    v_mfma_f32_32x32x16_bf16 v[64:79], v[40:43], a[204:207], v[64:79]
    ds_read_b64_tr_b16 v[60:61], v13 offset:20480
    ds_read_b64_tr_b16 v[62:63], v13 offset:21504
    s_waitcnt vmcnt(5)
    s_waitcnt lgkmcnt(4)
    v_mfma_f32_32x32x16_bf16 v[80:95], v[52:55], a[208:211], v[80:95]
    ds_read_b64_tr_b16 v[32:33], v8 offset:57344
    ds_read_b64_tr_b16 v[34:35], v8 offset:58368
    v_mfma_f32_32x32x16_bf16 v[64:79], v[48:51], a[208:211], v[64:79]
    ds_read_b64_tr_b16 v[36:37], v9 offset:57344
    ds_read_b64_tr_b16 v[38:39], v9 offset:58368
    s_waitcnt vmcnt(4)
    s_waitcnt lgkmcnt(4)
    v_mfma_f32_32x32x16_bf16 v[80:95], v[60:63], a[212:215], v[80:95]
    ds_read_b64_tr_b16 v[40:41], v10 offset:24576
    ds_read_b64_tr_b16 v[42:43], v10 offset:25600
    v_mfma_f32_32x32x16_bf16 v[64:79], v[56:59], a[212:215], v[64:79]
    ds_read_b64_tr_b16 v[44:45], v11 offset:24576
    ds_read_b64_tr_b16 v[46:47], v11 offset:25600
    s_waitcnt vmcnt(3)
    s_waitcnt lgkmcnt(4)
    v_mfma_f32_32x32x16_bf16 v[80:95], v[36:39], a[216:219], v[80:95]
    ds_read_b64_tr_b16 v[48:49], v10 offset:28672
    ds_read_b64_tr_b16 v[50:51], v10 offset:29696
    v_mfma_f32_32x32x16_bf16 v[64:79], v[32:35], a[216:219], v[64:79]
    ds_read_b64_tr_b16 v[52:53], v11 offset:28672
    ds_read_b64_tr_b16 v[54:55], v11 offset:29696
    s_waitcnt vmcnt(2)
    s_waitcnt lgkmcnt(4)
    v_mfma_f32_32x32x16_bf16 v[80:95], v[44:47], a[220:223], v[80:95]
    s_waitcnt vmcnt(1)
    s_waitcnt lgkmcnt(0)
    v_mfma_f32_32x32x16_bf16 v[80:95], v[52:55], a[224:227], v[80:95]
    v_mfma_f32_32x32x16_bf16 v[64:79], v[40:43], a[220:223], v[64:79]
    v_mfma_f32_32x32x16_bf16 v[64:79], v[48:51], a[224:227], v[64:79]
    s_nop 9
    ds_write_b128 v116, v[80:83]
    ds_write_b128 v117, v[84:87]
    ds_write_b128 v118, v[88:91]
    ds_write_b128 v119, v[92:95]
    ds_write_b128 v112, v[64:67]
    ds_write_b128 v113, v[68:71]
    ds_write_b128 v114, v[72:75]
    ds_write_b128 v115, v[76:79]
    s_waitcnt lgkmcnt(0)
    s_barrier
    ds_read_b128 v[128:131], v20 offset:0
    ds_read_b128 v[132:135], v21 offset:0
    ds_read_b128 v[136:139], v20 offset:16384
    ds_read_b128 v[140:143], v21 offset:16384
    ds_read_b128 v[144:147], v20 offset:2048
    ds_read_b128 v[148:151], v21 offset:2048
    ds_read_b128 v[152:155], v20 offset:18432
    ds_read_b128 v[156:159], v21 offset:18432
    s_waitcnt lgkmcnt(4)
    v_pk_add_f32 v[128:129], v[128:129], v[136:137]
    v_pk_add_f32 v[130:131], v[130:131], v[138:139]
    v_pk_add_f32 v[132:133], v[132:133], v[140:141]
    v_pk_add_f32 v[134:135], v[134:135], v[142:143]
    v_pk_add_f32 v[128:129], v[128:129], v[96:97]
    v_pk_add_f32 v[130:131], v[130:131], v[98:99]
    v_pk_add_f32 v[132:133], v[132:133], v[100:101]
    v_pk_add_f32 v[134:135], v[134:135], v[102:103]
    v_cvt_pk_bf16_f32 v120, v128, v129
    v_cvt_pk_bf16_f32 v121, v130, v131
    v_cvt_pk_bf16_f32 v122, v132, v133
    v_cvt_pk_bf16_f32 v123, v134, v135
    buffer_store_dwordx4 v[120:123], v0, s[28:31], 0 offen
    s_waitcnt lgkmcnt(0)
    v_pk_add_f32 v[144:145], v[144:145], v[152:153]
    v_pk_add_f32 v[146:147], v[146:147], v[154:155]
    v_pk_add_f32 v[148:149], v[148:149], v[156:157]
    v_pk_add_f32 v[150:151], v[150:151], v[158:159]
    v_pk_add_f32 v[144:145], v[144:145], v[104:105]
    v_pk_add_f32 v[146:147], v[146:147], v[106:107]
    v_pk_add_f32 v[148:149], v[148:149], v[108:109]
    v_pk_add_f32 v[150:151], v[150:151], v[110:111]
    v_cvt_pk_bf16_f32 v124, v144, v145
    v_cvt_pk_bf16_f32 v125, v146, v147
    v_cvt_pk_bf16_f32 v126, v148, v149
    v_cvt_pk_bf16_f32 v127, v150, v151
    buffer_store_dwordx4 v[124:127], v0, s[28:31], s90 offen
    s_endpgm
L_slow_1:
    s_mov_b32 s60, 100000
L_slow_1_l:
    buffer_load_dwordx2 v[160:161], v178, s[32:35], s62 offen sc1
    buffer_load_dwordx2 v[162:163], v178, s[32:35], s62 offen offset:256 sc1
    buffer_load_dword v164, v166, s[32:35], s74 offen sc1
    s_waitcnt vmcnt(0)
    v_xor_b32 v222, s41, v161
    v_xor_b32 v223, s41, v163
    v_or_b32 v222, v222, v223
    v_xor_b32 v223, s41, v164
    v_or_b32 v222, v222, v223
    v_cmp_ne_u32 vcc, 0, v222
    s_cbranch_vccz L_back_2
    s_sub_u32 s60, s60, 1
    s_cbranch_scc0 L_slow_1_l
    s_branch L_back_2
L_slow_3:
    s_mov_b32 s60, 100000
L_slow_3_l:
    buffer_load_dword v65, v167, s[32:35], s67 offen sc1
    s_waitcnt vmcnt(0)
    v_cmp_ne_u32 vcc, s41, v65
    s_cbranch_vccz L_back_4
    s_sub_u32 s60, s60, 1
    s_cbranch_scc0 L_slow_3_l
    s_branch L_back_4
L_slow_5:
    s_mov_b32 s60, 100000
L_slow_5_l:
    buffer_load_dword v15, v14, s[32:35], s68 offen sc1
    s_waitcnt vmcnt(0)
    v_cmp_ne_u32 vcc, s41, v15
    s_cbranch_vccz L_back_6
    s_sub_u32 s60, s60, 1
    s_cbranch_scc0 L_slow_5_l
    s_branch L_back_6
L_slow_7:
    s_mov_b32 s60, 100000
L_slow_7_l:
    buffer_load_dword v15, v14, s[24:27], s70 offen sc1
    s_waitcnt vmcnt(0)
    v_cmp_ne_u32 vcc, s41, v15
    s_cbranch_vccz L_back_8
    s_sub_u32 s60, s60, 1
    s_and_b32 s63, s60, 7
    s_cbranch_scc1 L_slow_7_l
    buffer_load_dword v15, v14, s[32:35], s70 offen sc1
    s_waitcnt vmcnt(0)
    v_cmp_ne_u32 vcc, s41, v15
    s_cbranch_vccz L_back_8
    s_sub_u32 s60, s60, 1
    s_cbranch_scc0 L_slow_7_l
    s_branch L_back_8
L_slow_9:
    s_mov_b32 s60, 100000
L_slow_9_l:
    buffer_load_dword v15, v14, s[32:35], s69 offen sc1
    s_waitcnt vmcnt(0)
    v_cmp_ne_u32 vcc, s41, v15
    s_cbranch_vccz L_back_10
    s_sub_u32 s60, s60, 1
    s_cbranch_scc0 L_slow_9_l
    s_branch L_back_10
L_slow_11:
    s_mov_b32 s60, 100000
L_slow_11_l:
    buffer_load_dwordx2 v[160:161], v178, s[32:35], s62 offen sc1
    buffer_load_dwordx2 v[162:163], v178, s[32:35], s62 offen offset:256 sc1
    s_waitcnt vmcnt(0)
    v_xor_b32 v222, s41, v161
    v_xor_b32 v223, s41, v163
    v_or_b32 v222, v222, v223
    v_cmp_ne_u32 vcc, 0, v222
    s_cbranch_vccz L_back_12
    s_sub_u32 s60, s60, 1
    s_cbranch_scc0 L_slow_11_l
    s_branch L_back_12
L_slow_13:
    s_mov_b32 s60, 100000
L_slow_13_l:
    buffer_load_dword v15, v14, s[24:27], s68 offen sc1
    s_waitcnt vmcnt(0)
    v_cmp_ne_u32 vcc, s41, v15
    s_cbranch_vccz L_back_14
    s_sub_u32 s60, s60, 1
    s_and_b32 s63, s60, 7
    s_cbranch_scc1 L_slow_13_l
    buffer_load_dword v15, v14, s[32:35], s68 offen sc1
    s_waitcnt vmcnt(0)
    v_cmp_ne_u32 vcc, s41, v15
    s_cbranch_vccz L_back_14
    s_sub_u32 s60, s60, 1
    s_cbranch_scc0 L_slow_13_l
    s_branch L_back_14
L_slow_15:
    s_mov_b32 s60, 100000
L_slow_15_l:
    buffer_load_dword v15, v14, s[24:27], s69 offen sc1
    s_waitcnt vmcnt(0)
    v_cmp_ne_u32 vcc, s41, v15
    s_cbranch_vccz L_back_16
    s_sub_u32 s60, s60, 1
    s_and_b32 s63, s60, 7
    s_cbranch_scc1 L_slow_15_l
    buffer_load_dword v15, v14, s[32:35], s69 offen sc1
    s_waitcnt vmcnt(0)
    v_cmp_ne_u32 vcc, s41, v15
    s_cbranch_vccz L_back_16
    s_sub_u32 s60, s60, 1
    s_cbranch_scc0 L_slow_15_l
    s_branch L_back_16
L_slow_17:
    s_mov_b32 s60, 100000
L_slow_17_l:
    buffer_load_dword v15, v14, s[32:35], s70 offen sc1
    s_waitcnt vmcnt(0)
    v_cmp_ne_u32 vcc, s41, v15
    s_cbranch_vccz L_back_18
    s_sub_u32 s60, s60, 1
    s_cbranch_scc0 L_slow_17_l
    s_branch L_back_18
L_end:
    s_endpgm
L_codeend:
.section .rodata,"a"
.p2align 6
.amdhsa_kernel parallel_sum__linear_attn_block__dense_activation_mish__prompt_kernel
  .amdhsa_next_free_vgpr 512
  .amdhsa_next_free_sgpr 102
  .amdhsa_accum_offset 256
  .amdhsa_group_segment_fixed_size 0
  .amdhsa_kernarg_size 80
  .amdhsa_user_sgpr_count 2
  .amdhsa_user_sgpr_kernarg_segment_ptr 1
  .amdhsa_system_sgpr_workgroup_id_x 1
  .amdhsa_float_denorm_mode_32 3
.end_amdhsa_kernel
```
